```python
import torch

def _softmax(x, axis=-1):
    return torch.softmax(x, dim=axis)
def _gelu(x):
    return torch.nn.functional.gelu(x, approximate="tanh")
def _silu(x):
    return torch.nn.functional.silu(x)
def _sigmoid(x):
    return torch.sigmoid(x)
def _layernorm(x, axis=-1, eps=1e-5):
    m = x.mean(dim=axis, keepdim=True)
    v = x.var(dim=axis, keepdim=True, unbiased=False)
    return (x - m) / torch.sqrt(v + eps)
def _scatter_add(tgt, idx, src, axis=0):
    return tgt.clone().index_add_(axis, idx, src)
def _segment_sum(src, seg, n):
    out = torch.zeros((n,) + src.shape[1:], dtype=src.dtype)
    return out.index_add_(0, seg, src)
def _pad(x, pw):
    flat = tuple(v for pair in reversed(pw) for v in pair)
    return torch.nn.functional.pad(x, flat)

kernel_name = 'standalone__self_sup_conv_stem_wavlm__speech'

def setup_inputs():

    _w = (lambda a: (lambda t: t.to(torch.bfloat16) if t.is_floating_point() else t)(torch.as_tensor(a)))
    B, T, D, K = 2, 4000, 256, 15
    scale = (K * D) ** -0.5
    return {
        "x": _w((lambda *s: torch.randn(*s, dtype=torch.bfloat16) * 0.05)(B, T, D)),
        "w": _w((lambda *s: torch.randn(*s, dtype=torch.bfloat16) * 0.05)(K, D, D) * scale),
        "gn_gamma": _w((lambda *s: torch.randn(*s, dtype=torch.bfloat16) * 0.05)(D) * 0.1 + 1.0),
        "gn_beta": _w((lambda *s: torch.randn(*s, dtype=torch.bfloat16) * 0.05)(D) * 0.1),
    }

def reference(x, w, gn_gamma, gn_beta):
    B, T, D = x.shape
    K = w.shape[0]
    s = 2
    L = (T - K) // s + 1
    h = torch.einsum('blc,cd->bld', x[:, 0:s * L:s, :], w[0])
    for i in range(1, K):
        h = h + torch.einsum('blc,cd->bld', x[:, i:i + s * L:s, :], w[i])
    mu = torch.einsum('bld->bd', h)[:, None, :] / L
    var = torch.einsum('bld->bd', (h - mu) ** 2)[:, None, :] / L
    h = (h - mu) / torch.sqrt(var + 1e-5)
    h = h * gn_gamma[None, None, :] + gn_beta[None, None, :]
    return _gelu(h)
```

```asm
; @launch grid=(256,1,1) block=(512,1,1) lds=154320
.amdgcn_target "amdgcn-amd-amdhsa--gfx950"
.text
.globl standalone__self_sup_conv_stem_wavlm__speech_kernel
.p2align 12
.p2align 8
.type standalone__self_sup_conv_stem_wavlm__speech_kernel,@function
standalone__self_sup_conv_stem_wavlm__speech_kernel:
    s_load_dwordx2 s[4:5], s[0:1], 0
    s_load_dwordx2 s[8:9], s[0:1], 8
    v_lshrrev_b32 v1, 6, v0
    v_and_b32 v2, 63, v0
    v_readfirstlane_b32 s3, v1
    s_cmp_ge_u32 s2, 0x100
    s_cbranch_scc1 L_end0
    s_lshr_b32 s32, s2, 3
    s_and_b32 s33, s2, 3
    s_bfe_u32 s34, s2, 0x10002
    s_mov_b32 s10, 1966080
    s_mov_b32 s11, 0x20000
    s_and_b32 s35, s32, 1
    s_lshl_b32 s45, s35, 1
    s_cmp_lt_u32 s3, 4
    s_cbranch_scc1 L_load
    s_sub_u32 s3, s3, 4
    s_getpc_b64 s[42:43]
    s_lshl_b32 s37, s32, 2
    s_add_u32 s37, s37, s3
    s_lshl_b32 s37, s37, 7
    s_addk_i32 s37, 0x380
    v_lshl_add_u32 v26, v2, 14, s37
    v_min_u32 v26, L_last-.-128, v26
    v_mov_b32 v27, s43
    v_add_co_u32 v26, vcc, s42, v26
    s_mov_b64 exec, 3
    s_nop 0
    v_addc_co_u32 v27, vcc, 0, v27, vcc
    global_load_dword v30, v[26:27], off
    s_mov_b64 exec, -1
    v_and_b32 v5, 15, v2
    v_lshrrev_b32 v6, 4, v2
    s_branch L_cons
L_end0:
    s_endpgm
L_load:
    s_setprio 1
    s_mul_i32 s36, s34, 2048000
    s_add_u32 s6, s36, 2047488
    s_mov_b32 s7, 0x20000
    s_lshr_b32 s37, s32, 1
    s_lshl_b32 s37, s37, 17
    s_add_u32 s36, s36, s37
    v_lshrrev_b32 v5, 3, v2
    v_and_b32 v6, 7, v2
    v_lshlrev_b32 v6, 4, v6
    v_and_b32 v7, 32, v2
    v_xor_b32 v7, v7, v6
    v_and_b32 v8, 4, v5
    v_add_u32 v8, v8, v5
    v_lshl_add_u32 v7, v8, 10, v7
    s_lshl_b32 s37, s3, 15
    s_add_u32 s37, s37, s36
    v_add_u32 v10, s37, v7
    v_add_u32 v11, 15296, v10
    s_lshl_b32 s37, s3, 11
    s_add_u32 s37, s37, s36
    s_add_u32 s37, s37, 126976
    v_add_u32 v12, s37, v7
    v_and_b32 v9, 2, v5
    v_lshlrev_b32 v9, 4, v9
    v_xor_b32 v8, v6, v9
    v_lshl_add_u32 v8, v5, 9, v8
    s_lshl_b32 s37, s3, 13
    s_lshl_b32 s39, s33, 7
    s_add_u32 s37, s37, s39
    v_add_u32 v15, s37, v8
    v_xor_b32 v9, 64, v15
    v_add_u32 v9, 0xc00, v9
    s_mul_i32 s42, s3, 2176
    s_lshl_b32 s43, s3, 8
    s_lshl_b32 s44, s3, 11
    s_add_u32 s44, s44, 55488
    s_lshl_b32 s47, s45, 7
    s_lshl_b32 s48, s45, 15
    s_mov_b32 m0, s42
    s_waitcnt lgkmcnt(0)
    buffer_load_dwordx4 v10, s[4:7], s47 offen offset:0 lds
    buffer_load_dwordx4 v11, s[4:7], s47 offen offset:1088 lds
    s_add_u32 m0, s44, 0
    s_add_u32 s46, s48, 0
    buffer_load_dwordx4 v15, s[8:11], s46 offen lds
    buffer_load_dwordx4 v9, s[8:11], s46 offen offset:1024 lds
    s_add_u32 m0, s42, 9728
    s_xor_b32 s47, s47, 4096
    buffer_load_dwordx4 v10, s[4:7], s47 offen offset:0 lds
    buffer_load_dwordx4 v11, s[4:7], s47 offen offset:1088 lds
    s_add_u32 m0, s43, 8704
    s_mov_b64 exec, 0xffff
    buffer_load_dwordx4 v12, s[4:7], s47 offen lds
    s_mov_b64 exec, -1
    s_add_u32 m0, s44, 8192
    s_add_u32 s46, s48, 262144
    buffer_load_dwordx4 v15, s[8:11], s46 offen lds
    buffer_load_dwordx4 v9, s[8:11], s46 offen offset:1024 lds
    s_load_dwordx2 s[12:13], s[0:1], 16
    s_load_dwordx2 s[16:17], s[0:1], 24
    s_load_dwordx2 s[20:21], s[0:1], 32
    s_load_dwordx2 s[24:25], s[0:1], 40
    s_load_dwordx2 s[28:29], s[0:1], 48
    s_add_u32 s22, s34, 1
    s_mul_i32 s22, s22, 1020416
    s_mov_b32 s23, 0x20000
    s_mov_b32 s30, 2359296
    s_mov_b32 s31, 0x20000
    s_and_b32 s38, s2, 7
    v_and_b32 v4, 31, v0
    v_lshrrev_b32 v7, 5, v0
    v_mul_u32_u24 v3, 272, v4
    v_lshl_add_u32 v3, v7, 4, v3
    v_add_u32 v3, 18496, v3
    v_lshrrev_b32 v1, 2, v7
    v_and_b32 v7, 3, v7
    v_lshl_add_u32 v7, v1, 5, v7
    v_lshlrev_b32 v7, 9, v7
    v_lshl_add_u32 v7, v4, 2, v7
    s_mul_i32 s37, s34, 1993
    s_lshl_b32 s39, s32, 6
    s_add_u32 s37, s37, s39
    s_mul_i32 s39, s35, 60
    s_sub_u32 s37, s37, s39
    s_lshl_b32 s37, s37, 9
    s_lshl_b32 s39, s33, 7
    s_add_u32 s37, s37, s39
    v_add_u32 v7, s37, v7
    v_lshlrev_b32 v4, 4, v4
    v_add_u32 v4, 35968, v4
    s_mov_b32 s56, 0x3eeff558
    s_mov_b32 s57, 0x409d30fc
    s_lshl_b32 s37, s38, 2
    s_add_u32 s37, s37, s3
    s_lshl_b32 s54, s37, 12
    s_lshl_b32 s37, s32, 7
    s_add_u32 s49, s37, s54
    s_lshl_b32 s55, s38, 5
    v_mov_b32 v34, s55
    s_movk_i32 s14, 512
    s_mov_b32 s15, 0x20000
    s_movk_i32 s18, 512
    s_mov_b32 s19, 0x20000
    s_movk_i32 s26, 256
    s_mov_b32 s27, 0x20000
    v_and_b32 v5, 15, v2
    v_lshrrev_b32 v6, 4, v2
    v_xor_b32 v29, s45, v6
    v_lshlrev_b32 v29, 15, v29
    v_lshl_add_u32 v29, v5, 17, v29
    s_lshr_b32 s37, s32, 1
    s_lshl_b32 s37, s37, 2
    s_add_u32 s37, s37, s3
    s_lshl_b32 s37, s37, 9
    s_lshl_b32 s39, s33, 7
    s_add_u32 s37, s37, s39
    v_add_u32 v29, s37, v29
    v_and_b32 v13, 31, v2
    v_lshl_add_u32 v13, v13, 2, s49
    s_lshl_b32 s37, s2, 2
    s_add_u32 s37, s37, s3
    s_lshl_b32 s37, s37, 11
    s_add_u32 s37, s37, 262144
    v_lshl_add_u32 v16, v2, 7, s37
    v_cmp_gt_u32 vcc, 16, v2
    v_mov_b32 v44, -1
    v_mov_b32 v45, -1
    v_mov_b32 v46, -1
    v_mov_b32 v47, -1
    v_lshl_add_u32 v17, v2, 4, s37
    v_cndmask_b32 v16, v13, v16, vcc
    v_and_b32 v14, 32, v2
    v_lshl_add_u32 v13, v14, 12, v13
    v_and_b32 v18, 7, v2
    v_lshrrev_b32 v19, 5, v2
    v_lshl_add_u32 v18, v18, 1, v19
    s_lshl_b32 s39, s3, 4
    v_add_u32 v18, s39, v18
    s_lshl_b32 s37, s33, 6
    v_add_lshl_u32 v33, v18, s37, 1
    v_and_b32 v19, 1, v6
    v_lshlrev_b32 v18, 3, v18
    v_lshl_add_u32 v18, v19, 2, v18
    v_add_u32 v35, 35968, v18
    v_cmp_eq_u32 s[52:53], 1, v19
    v_cvt_f32_u32 v36, v19
    v_mul_f32 v36, 0x3727c5ac, v36
    s_getreg_b32 s41, hwreg(HW_REG_XCC_ID, 0, 4)
    s_mul_i32 s37, s41, s41
    s_lshl_b32 s37, s37, 10
    s_add_u32 s41, s41, s37
    s_lshl_b32 s41, s41, 8
    s_add_u32 s41, s41, 1
    s_waitcnt lgkmcnt(0)
    s_mov_b64 exec, 0x7ffa
    buffer_load_dword v43, v29, s[8:11], 0 offen
    s_mov_b64 exec, -1
    s_cmp_eq_u32 s35, 1
    s_cbranch_scc1 L_stub1
    s_branch L_stub0
L_stubback:
    s_add_u32 m0, s44, 16384
    s_add_u32 s46, s48, 524288
    buffer_load_dwordx4 v15, s[8:11], s46 offen lds
    buffer_load_dwordx4 v9, s[8:11], s46 offen offset:1024 lds
    s_add_u32 m0, s44, 24576
    s_add_u32 s46, s48, 786432
    buffer_load_dwordx4 v15, s[8:11], s46 offen lds
    buffer_load_dwordx4 v9, s[8:11], s46 offen offset:1024 lds
    s_waitcnt vmcnt(10)
    s_barrier
    s_waitcnt vmcnt(7)
    s_barrier
    s_add_u32 m0, s44, 32768
    s_add_u32 s46, s48, 1048576
    buffer_load_dwordx4 v15, s[8:11], s46 offen lds
    buffer_load_dwordx4 v9, s[8:11], s46 offen offset:1024 lds
    s_add_u32 m0, s44, 40960
    s_add_u32 s46, s48, 1310720
    buffer_load_dwordx4 v15, s[8:11], s46 offen lds
    buffer_load_dwordx4 v9, s[8:11], s46 offen offset:1024 lds
    s_waitcnt vmcnt(9)
    s_barrier
    s_add_u32 m0, s44, 49152
    s_add_u32 s46, s48, 1572864
    buffer_load_dwordx4 v15, s[8:11], s46 offen lds
    buffer_load_dwordx4 v9, s[8:11], s46 offen offset:1024 lds
    s_add_u32 m0, s42, 18496
    s_xor_b32 s47, s47, 4608
    buffer_load_dwordx4 v10, s[4:7], s47 offen offset:0 lds
    buffer_load_dwordx4 v11, s[4:7], s47 offen offset:1088 lds
    s_waitcnt vmcnt(10)
    s_barrier
    s_add_u32 m0, s42, 28224
    s_xor_b32 s47, s47, 4096
    buffer_load_dwordx4 v10, s[4:7], s47 offen offset:0 lds
    buffer_load_dwordx4 v11, s[4:7], s47 offen offset:1088 lds
    s_add_u32 m0, s43, 27200
    s_mov_b64 exec, 0xffff
    buffer_load_dwordx4 v12, s[4:7], s47 offen lds
    s_mov_b64 exec, -1
    s_waitcnt vmcnt(11)
    s_barrier
    buffer_store_dwordx4 v[44:47], v17, s[28:31], 0 offen
    buffer_store_dwordx4 v[44:47], v17, s[28:31], 0 offen offset:1024
    buffer_store_dword v44, v13, s[28:31], 0 offen sc1
    s_waitcnt vmcnt(12)
    s_barrier
    s_add_u32 m0, s44, 57344
    s_add_u32 s46, s48, 1835008
    buffer_load_dwordx4 v15, s[8:11], s46 offen lds
    buffer_load_dwordx4 v9, s[8:11], s46 offen offset:1024 lds
    s_waitcnt vmcnt(12)
    s_barrier
    s_waitcnt vmcnt(10)
    s_barrier
    s_add_u32 m0, s44, 65536
    s_add_u32 s46, s48, 131072
    buffer_load_dwordx4 v15, s[8:11], s46 offen lds
    buffer_load_dwordx4 v9, s[8:11], s46 offen offset:1024 lds
    s_add_u32 m0, s44, 73728
    s_add_u32 s46, s48, 393216
    buffer_load_dwordx4 v15, s[8:11], s46 offen lds
    buffer_load_dwordx4 v9, s[8:11], s46 offen offset:1024 lds
    s_add_u32 m0, s44, 81920
    s_add_u32 s46, s48, 655360
    buffer_load_dwordx4 v15, s[8:11], s46 offen lds
    buffer_load_dwordx4 v9, s[8:11], s46 offen offset:1024 lds
    s_add_u32 m0, s44, 90112
    s_add_u32 s46, s48, 917504
    buffer_load_dwordx4 v15, s[8:11], s46 offen lds
    buffer_load_dwordx4 v9, s[8:11], s46 offen offset:1024 lds
    s_waitcnt vmcnt(6)
    s_barrier
    s_cmp_lg_u32 s3, 0
    s_cbranch_scc1 L_noatoma
    s_atomic_add s41, s[24:25], s55
L_noatoma:
    s_add_u32 m0, s44, 0
    s_add_u32 s46, s48, 1179648
    buffer_load_dwordx4 v15, s[8:11], s46 offen lds
    buffer_load_dwordx4 v9, s[8:11], s46 offen offset:1024 lds
    s_add_u32 m0, s44, 8192
    s_add_u32 s46, s48, 1441792
    buffer_load_dwordx4 v15, s[8:11], s46 offen lds
    buffer_load_dwordx4 v9, s[8:11], s46 offen offset:1024 lds
    s_add_u32 m0, s44, 16384
    s_add_u32 s46, s48, 1703936
    buffer_load_dwordx4 v15, s[8:11], s46 offen lds
    buffer_load_dwordx4 v9, s[8:11], s46 offen offset:1024 lds
    s_waitcnt vmcnt(4)
    s_barrier
    s_cmp_eq_u32 s35, 0
    s_cselect_b32 exec_hi, 0x55500000, 0
    s_or_b32 exec_lo, exec_hi, 0x8000
    buffer_load_dword v43, v29, s[8:11], 0 offen
    s_mov_b64 exec, -1
    s_add_u32 m0, s42, 36992
    s_xor_b32 s47, s47, 4736
    buffer_load_dwordx4 v10, s[4:7], s47 offen offset:0 lds
    buffer_load_dwordx4 v11, s[4:7], s47 offen offset:1088 lds
    s_add_u32 m0, s42, 46720
    s_xor_b32 s47, s47, 4096
    buffer_load_dwordx4 v10, s[4:7], s47 offen offset:0 lds
    buffer_load_dwordx4 v11, s[4:7], s47 offen offset:1088 lds
    s_add_u32 m0, s43, 45696
    s_mov_b64 exec, 0xffff
    buffer_load_dwordx4 v12, s[4:7], s47 offen lds
    s_mov_b64 exec, -1
    s_xor_b32 s48, s48, 32768
    s_add_u32 m0, s44, 24576
    s_add_u32 s46, s48, 0
    buffer_load_dwordx4 v15, s[8:11], s46 offen lds
    buffer_load_dwordx4 v9, s[8:11], s46 offen offset:1024 lds
    s_add_u32 m0, s44, 32768
    s_add_u32 s46, s48, 262144
    buffer_load_dwordx4 v15, s[8:11], s46 offen lds
    buffer_load_dwordx4 v9, s[8:11], s46 offen offset:1024 lds
    s_waitcnt vmcnt(12)
    s_barrier
    s_add_u32 m0, s44, 40960
    s_add_u32 s46, s48, 524288
    buffer_load_dwordx4 v15, s[8:11], s46 offen lds
    buffer_load_dwordx4 v9, s[8:11], s46 offen offset:1024 lds
    s_add_u32 m0, s44, 49152
    s_add_u32 s46, s48, 786432
    buffer_load_dwordx4 v15, s[8:11], s46 offen lds
    buffer_load_dwordx4 v9, s[8:11], s46 offen offset:1024 lds
    s_waitcnt vmcnt(14)
    s_barrier
    s_add_u32 m0, s44, 57344
    s_add_u32 s46, s48, 1048576
    buffer_load_dwordx4 v15, s[8:11], s46 offen lds
    buffer_load_dwordx4 v9, s[8:11], s46 offen offset:1024 lds
    s_add_u32 m0, s44, 65536
    s_add_u32 s46, s48, 1310720
    buffer_load_dwordx4 v15, s[8:11], s46 offen lds
    buffer_load_dwordx4 v9, s[8:11], s46 offen offset:1024 lds
    s_waitcnt vmcnt(10)
    s_barrier
    s_add_u32 m0, s44, 73728
    s_add_u32 s46, s48, 1572864
    buffer_load_dwordx4 v15, s[8:11], s46 offen lds
    buffer_load_dwordx4 v9, s[8:11], s46 offen offset:1024 lds
    s_waitcnt vmcnt(8)
    s_barrier
    s_mov_b64 exec, 0x2aa80000
    buffer_load_dword v43, v29, s[8:11], 0 offen
    s_mov_b64 exec, -1
    s_add_u32 m0, s42, 0
    s_xor_b32 s47, s47, 4608
    buffer_load_dwordx4 v10, s[4:7], s47 offen offset:0 lds
    buffer_load_dwordx4 v11, s[4:7], s47 offen offset:1088 lds
    s_add_u32 m0, s42, 9728
    s_xor_b32 s47, s47, 4096
    buffer_load_dwordx4 v10, s[4:7], s47 offen offset:0 lds
    buffer_load_dwordx4 v11, s[4:7], s47 offen offset:1088 lds
    s_add_u32 m0, s43, 8704
    s_mov_b64 exec, 0xffff
    buffer_load_dwordx4 v12, s[4:7], s47 offen lds
    s_mov_b64 exec, -1
    s_lshl_b32 s37, s3, 2
    s_add_u32 m0, s37, 153792
    s_mov_b64 exec, 1
    buffer_load_dword v34, s[24:27], 0 offen sc1 lds
    s_mov_b64 exec, -1
    s_add_u32 m0, s44, 81920
    s_add_u32 s46, s48, 1835008
    buffer_load_dwordx4 v15, s[8:11], s46 offen lds
    buffer_load_dwordx4 v9, s[8:11], s46 offen offset:1024 lds
    s_waitcnt vmcnt(11)
    s_barrier
    s_add_u32 m0, s44, 90112
    s_add_u32 s46, s48, 131072
    buffer_load_dwordx4 v15, s[8:11], s46 offen lds
    buffer_load_dwordx4 v9, s[8:11], s46 offen offset:1024 lds
    s_add_u32 m0, s44, 0
    s_add_u32 s46, s48, 393216
    buffer_load_dwordx4 v15, s[8:11], s46 offen lds
    buffer_load_dwordx4 v9, s[8:11], s46 offen offset:1024 lds
    s_waitcnt vmcnt(13)
    s_barrier
    s_add_u32 m0, s44, 8192
    s_add_u32 s46, s48, 655360
    buffer_load_dwordx4 v15, s[8:11], s46 offen lds
    buffer_load_dwordx4 v9, s[8:11], s46 offen offset:1024 lds
    s_add_u32 m0, s44, 16384
    s_add_u32 s46, s48, 917504
    buffer_load_dwordx4 v15, s[8:11], s46 offen lds
    buffer_load_dwordx4 v9, s[8:11], s46 offen offset:1024 lds
    s_waitcnt vmcnt(8)
    s_barrier
    s_add_u32 m0, s44, 24576
    s_add_u32 s46, s48, 1179648
    buffer_load_dwordx4 v15, s[8:11], s46 offen lds
    buffer_load_dwordx4 v9, s[8:11], s46 offen offset:1024 lds
    s_add_u32 m0, s44, 32768
    s_add_u32 s46, s48, 1441792
    buffer_load_dwordx4 v15, s[8:11], s46 offen lds
    buffer_load_dwordx4 v9, s[8:11], s46 offen offset:1024 lds
    s_waitcnt vmcnt(10)
    s_barrier
    s_add_u32 m0, s44, 40960
    s_add_u32 s46, s48, 1703936
    buffer_load_dwordx4 v15, s[8:11], s46 offen lds
    buffer_load_dwordx4 v9, s[8:11], s46 offen offset:1024 lds
    s_waitcnt vmcnt(10)
    s_barrier
    buffer_load_dword v43, v16, s[28:31], 0 offen
    buffer_load_ushort v40, v33, s[12:15], 0 offen
    buffer_load_ushort v41, v33, s[16:19], 0 offen
    s_waitcnt vmcnt(9)
    s_barrier
    s_waitcnt vmcnt(5)
    s_barrier
    s_waitcnt vmcnt(3)
    s_barrier
    s_branch L_ltail
.p2align 12
L_ltail:
    v_lshl_add_u32 v15, v2, 4, s54
    s_mov_b32 s51, 0
    s_mov_b32 s50, 0
    s_and_b32 s37, s32, 7
    s_lshl_b32 s37, s37, 3
    s_lshl_b64 s[96:97], 0xff, s37
    s_not_b64 s[96:97], s[96:97]
    s_lshr_b32 s98, s32, 3
    s_cmp_eq_u32 s98, 0
    s_cselect_b64 s[4:5], s[96:97], -1
    s_cmp_eq_u32 s98, 1
    s_cselect_b64 s[6:7], s[96:97], -1
    s_cmp_eq_u32 s98, 2
    s_cselect_b64 s[8:9], s[96:97], -1
    s_cmp_eq_u32 s98, 3
    s_cselect_b64 s[10:11], s[96:97], -1
    v_mov_b32 v80, 0
    v_mov_b32 v81, 0
    v_mov_b32 v82, 0
    v_mov_b32 v83, 0
    v_cndmask_b32 v64, 0, -1, s[4:5]
    v_cndmask_b32 v65, 0, -1, s[4:5]
    v_cndmask_b32 v66, 0, -1, s[4:5]
    v_cndmask_b32 v67, 0, -1, s[4:5]
    v_cndmask_b32 v68, 0, -1, s[6:7]
    v_cndmask_b32 v69, 0, -1, s[6:7]
    v_cndmask_b32 v70, 0, -1, s[6:7]
    v_cndmask_b32 v71, 0, -1, s[6:7]
    v_cndmask_b32 v72, 0, -1, s[8:9]
    v_cndmask_b32 v73, 0, -1, s[8:9]
    v_cndmask_b32 v74, 0, -1, s[8:9]
    v_cndmask_b32 v75, 0, -1, s[8:9]
    v_cndmask_b32 v76, 0, -1, s[10:11]
    v_cndmask_b32 v77, 0, -1, s[10:11]
    v_cndmask_b32 v78, 0, -1, s[10:11]
    v_cndmask_b32 v79, 0, -1, s[10:11]
    s_lshl_b32 s37, s3, 7
    s_add_u32 s37, s37, 153808
    v_lshl_add_u32 v11, v2, 4, s37
    s_waitcnt vmcnt(0)
    v_lshlrev_b32 v40, 16, v40
    v_lshlrev_b32 v41, 16, v41
    v_cndmask_b32 v41, 0, v41, s[52:53]
    v_mul_f32 v40, s56, v40
    v_mul_f32 v41, s56, v41
    s_mov_b32 s50, 0
    s_mov_b32 s46, 0
    s_mov_b32 s47, 0x3a038849
    s_setprio 3
    s_barrier
    s_mov_b64 exec, s[4:5]
    buffer_load_dwordx4 v[64:67], v15, s[28:31], 0 offen offset:0 sc1
    s_mov_b64 exec, s[6:7]
    buffer_load_dwordx4 v[68:71], v15, s[28:31], 0 offen offset:1024 sc1
    s_mov_b64 exec, s[8:9]
    buffer_load_dwordx4 v[72:75], v15, s[28:31], 0 offen offset:2048 sc1
    s_mov_b64 exec, s[10:11]
    buffer_load_dwordx4 v[76:79], v15, s[28:31], 0 offen offset:3072 sc1
    s_mov_b64 exec, -1
    s_mov_b64 exec, 0xff
    ds_read_b128 v[80:83], v11
    s_mov_b64 exec, -1
    ds_read_b128 v[16:19], v3
    ds_read_b128 v[20:23], v3 offset:8768
    s_waitcnt lgkmcnt(0)
L_poll:
    s_or_b64 s[12:13], s[6:7], s[8:9]
    s_or_b64 s[12:13], s[12:13], s[10:11]
    s_waitcnt vmcnt(3)
    v_cmp_eq_u32 s[4:5], -1, v64
    s_or_b64 s[12:13], s[12:13], s[4:5]
    s_cbranch_scc0 L_sum
    s_mov_b64 exec, s[4:5]
    buffer_load_dwordx4 v[64:67], v15, s[28:31], 0 offen offset:0 sc1
    s_mov_b64 exec, -1
    s_or_b64 s[12:13], s[8:9], s[10:11]
    s_or_b64 s[12:13], s[12:13], s[4:5]
    s_waitcnt vmcnt(3)
    v_cmp_eq_u32 s[6:7], -1, v68
    s_or_b64 s[12:13], s[12:13], s[6:7]
    s_cbranch_scc0 L_sum
    s_mov_b64 exec, s[6:7]
    buffer_load_dwordx4 v[68:71], v15, s[28:31], 0 offen offset:1024 sc1
    s_mov_b64 exec, -1
    s_or_b64 s[12:13], s[10:11], s[4:5]
    s_or_b64 s[12:13], s[12:13], s[6:7]
    s_waitcnt vmcnt(3)
    v_cmp_eq_u32 s[8:9], -1, v72
    s_or_b64 s[12:13], s[12:13], s[8:9]
    s_cbranch_scc0 L_sum
    s_mov_b64 exec, s[8:9]
    buffer_load_dwordx4 v[72:75], v15, s[28:31], 0 offen offset:2048 sc1
    s_mov_b64 exec, -1
    s_or_b64 s[12:13], s[4:5], s[6:7]
    s_or_b64 s[12:13], s[12:13], s[8:9]
    s_waitcnt vmcnt(3)
    v_cmp_eq_u32 s[10:11], -1, v76
    s_or_b64 s[12:13], s[12:13], s[10:11]
    s_cbranch_scc1 L_again3
L_sum:
    v_pk_add_f32 v[44:45], v[64:65], v[68:69]
    v_pk_add_f32 v[46:47], v[66:67], v[70:71]
    v_pk_add_f32 v[48:49], v[72:73], v[76:77]
    v_pk_add_f32 v[50:51], v[74:75], v[78:79]
    v_pk_add_f32 v[44:45], v[44:45], v[80:81]
    v_pk_add_f32 v[46:47], v[46:47], v[82:83]
    v_pk_add_f32 v[44:45], v[44:45], v[48:49]
    v_pk_add_f32 v[46:47], v[46:47], v[50:51]
    s_nop 1
    v_permlane32_swap_b32 v44, v46
    v_permlane32_swap_b32 v45, v47
    v_pk_add_f32 v[44:45], v[44:45], v[46:47]
    s_nop 1
    v_permlane16_swap_b32 v44, v45
    v_add_f32 v44, v44, v45
    v_cmp_u_f32 vcc, v44, v44
    s_cbranch_vccnz L_nan
L_cont:
    v_add_f32_dpp v44, v44, v44 row_ror:8 row_mask:0xf bank_mask:0xf
    v_fma_f32 v45, v44, s47, v36
    v_fma_f32 v44, v44, s47, v36
    s_nop 1
    v_permlane16_swap_b32 v44, v45
    v_fma_f32 v45, -v44, v44, v45
    v_cndmask_b32_e64 v44, 1.0, -v44, s[52:53]
    v_max_f32 v45, 0x3727c5ac, v45
    v_rsq_f32 v45, v45
    v_mul_f32 v44, v44, v40
    v_fma_f32 v45, v45, v44, v41
    ds_write_b32 v35, v45
L_e2:
    s_waitcnt lgkmcnt(0)
    s_barrier
    ds_read_b128 v[24:27], v4
    v_add_u32 v48, 0x1000, v7
    v_add_u32 v49, 0x2000, v7
    v_add_u32 v50, 0x3000, v7
    s_waitcnt lgkmcnt(0)
    v_pk_fma_f32 v[16:17], v[16:17], v[24:25], v[24:25] op_sel:[0,0,1] op_sel_hi:[1,0,1]
    v_pk_fma_f32 v[20:21], v[20:21], v[26:27], v[26:27] op_sel:[0,0,1] op_sel_hi:[1,0,1]
    v_pk_fma_f32 v[32:33], v[16:17], v[16:17], s[56:57] op_sel:[0,0,1] op_sel_hi:[1,1,1]
    v_pk_fma_f32 v[36:37], v[20:21], v[20:21], s[56:57] op_sel:[0,0,1] op_sel_hi:[1,1,1]
    v_pk_mul_f32 v[32:33], v[32:33], v[16:17] neg_lo:[0,1] neg_hi:[0,1]
    v_pk_mul_f32 v[36:37], v[36:37], v[20:21] neg_lo:[0,1] neg_hi:[0,1]
    v_exp_f32 v32, v32
    v_exp_f32 v33, v33
    v_exp_f32 v36, v36
    v_exp_f32 v37, v37
    v_pk_fma_f32 v[32:33], v[32:33], s[56:57], s[56:57] op_sel:[0,0,0] op_sel_hi:[1,0,0]
    v_pk_fma_f32 v[36:37], v[36:37], s[56:57], s[56:57] op_sel:[0,0,0] op_sel_hi:[1,0,0]
    v_rcp_f32 v32, v32
    v_rcp_f32 v33, v33
    v_rcp_f32 v36, v36
    v_rcp_f32 v37, v37
    v_pk_mul_f32 v[16:17], v[32:33], v[16:17]
    v_pk_mul_f32 v[20:21], v[36:37], v[20:21]
    v_cvt_pk_bf16_f32 v40, v16, v20
    buffer_store_dword v40, v7, s[20:23], 0 offen nt
    v_cvt_pk_bf16_f32 v41, v17, v21
    buffer_store_dword v41, v48, s[20:23], 0 offen nt
    v_pk_fma_f32 v[18:19], v[18:19], v[24:25], v[24:25] op_sel:[0,0,1] op_sel_hi:[1,0,1]
    v_pk_fma_f32 v[22:23], v[22:23], v[26:27], v[26:27] op_sel:[0,0,1] op_sel_hi:[1,0,1]
    v_pk_fma_f32 v[34:35], v[18:19], v[18:19], s[56:57] op_sel:[0,0,1] op_sel_hi:[1,1,1]
    v_pk_fma_f32 v[38:39], v[22:23], v[22:23], s[56:57] op_sel:[0,0,1] op_sel_hi:[1,1,1]
    v_pk_mul_f32 v[34:35], v[34:35], v[18:19] neg_lo:[0,1] neg_hi:[0,1]
    v_pk_mul_f32 v[38:39], v[38:39], v[22:23] neg_lo:[0,1] neg_hi:[0,1]
    v_exp_f32 v34, v34
    v_exp_f32 v35, v35
    v_exp_f32 v38, v38
    v_exp_f32 v39, v39
    v_pk_fma_f32 v[34:35], v[34:35], s[56:57], s[56:57] op_sel:[0,0,0] op_sel_hi:[1,0,0]
    v_pk_fma_f32 v[38:39], v[38:39], s[56:57], s[56:57] op_sel:[0,0,0] op_sel_hi:[1,0,0]
    v_rcp_f32 v34, v34
    v_rcp_f32 v35, v35
    v_rcp_f32 v38, v38
    v_rcp_f32 v39, v39
    v_pk_mul_f32 v[18:19], v[34:35], v[18:19]
    v_pk_mul_f32 v[22:23], v[38:39], v[22:23]
    v_cvt_pk_bf16_f32 v42, v18, v22
    buffer_store_dword v42, v49, s[20:23], 0 offen nt
    v_cvt_pk_bf16_f32 v43, v19, v23
    buffer_store_dword v43, v50, s[20:23], 0 offen nt
L_end:
    s_endpgm
L_again:
    s_mov_b64 exec, s[4:5]
    buffer_load_dwordx4 v[64:67], v15, s[28:31], 0 offen offset:0 sc1
    s_mov_b64 exec, s[6:7]
    buffer_load_dwordx4 v[68:71], v15, s[28:31], 0 offen offset:1024 sc1
    s_mov_b64 exec, s[8:9]
    buffer_load_dwordx4 v[72:75], v15, s[28:31], 0 offen offset:2048 sc1
L_again3:
    s_mov_b64 exec, s[10:11]
    buffer_load_dwordx4 v[76:79], v15, s[28:31], 0 offen offset:3072 sc1
    s_mov_b64 exec, -1
    s_add_u32 s50, s50, 1
    s_cmp_ge_u32 s50, 0x80000
    s_cbranch_scc0 L_poll
    s_branch L_giveup
L_nan:
    s_cmp_eq_u32 s46, 1
    s_cbranch_scc1 L_cont
    s_waitcnt vmcnt(0)
    v_max3_u32 v46, v64, v65, v66
    v_max3_u32 v46, v46, v67, v68
    v_max3_u32 v46, v46, v69, v70
    v_max3_u32 v46, v46, v71, v72
    v_max3_u32 v46, v46, v73, v74
    v_max3_u32 v46, v46, v75, v76
    v_max3_u32 v46, v46, v77, v78
    v_max_u32 v46, v46, v79
    v_cmp_eq_u32 vcc, -1, v46
    s_cbranch_vccz L_giveup
    s_cmp_eq_u32 s98, 0
    s_cselect_b64 s[4:5], s[96:97], -1
    s_cmp_eq_u32 s98, 1
    s_cselect_b64 s[6:7], s[96:97], -1
    s_cmp_eq_u32 s98, 2
    s_cselect_b64 s[8:9], s[96:97], -1
    s_cmp_eq_u32 s98, 3
    s_cselect_b64 s[10:11], s[96:97], -1
    v_cndmask_b32 v64, v64, -1, s[4:5]
    v_cndmask_b32 v68, v68, -1, s[6:7]
    v_cndmask_b32 v72, v72, -1, s[8:9]
    v_cndmask_b32 v76, v76, -1, s[10:11]
    s_branch L_again
L_giveup:
    s_mov_b32 s46, 1
    s_branch L_sum
L_slx0_0:
    buffer_store_dwordx4 v[48:51], v20, s[28:31], 0 offen offset:0 sc1
    s_branch L_bkx0_0
L_slx1_0:
    buffer_store_dwordx4 v[56:59], v20, s[28:31], 0 offen offset:1024 sc1
    s_branch L_bkx1_0
L_decslow_0:
    s_and_b32 s37, s40, 0xff
    s_cmp_ge_u32 s37, 32
    s_cbranch_scc1 L_decfin_0
    s_add_u32 s39, s39, 1
    s_cmp_ge_u32 s39, 0x40000
    s_cbranch_scc1 L_decfin_0
    buffer_load_dword v19, v31, s[24:27], 0 offen sc1
    s_waitcnt vmcnt(0)
    v_readfirstlane_b32 s40, v19
    s_nop 3
    s_branch L_decslow_0
L_decfin_0:
    s_cmp_lg_u32 s40, s41
    s_branch L_decback_0
L_hs_0:
    v_add_u32 v21, 131072, v14
    s_waitcnt vmcnt(0)
    buffer_store_dword v2, v21, s[28:31], 0 offen sc1
    v_xor_b32 v21, 0x80, v21
L_hsp_0:
    buffer_load_dword v19, v21, s[28:31], 0 offen sc1
    v_add_u32 v17, 1, v17
    v_cmp_lt_u32 vcc, 0x80000, v17
    s_waitcnt vmcnt(0)
    s_cbranch_vccnz L_hsback_0
    v_cmp_eq_u32 vcc, -1, v19
    s_cbranch_vccnz L_hsp_0
    s_branch L_hsback_0
L_ps_0:
    buffer_store_dword v24, v14, s[28:31], 0 offen sc1
    s_branch L_psback_0
L_slx0_1:
    buffer_store_dwordx4 v[32:35], v20, s[28:31], 0 offen offset:0 sc1
    s_branch L_bkx0_1
L_slx1_1:
    buffer_store_dwordx4 v[40:43], v20, s[28:31], 0 offen offset:1024 sc1
    s_branch L_bkx1_1
L_decslow_1:
    s_and_b32 s37, s40, 0xff
    s_cmp_ge_u32 s37, 32
    s_cbranch_scc1 L_decfin_1
    s_add_u32 s39, s39, 1
    s_cmp_ge_u32 s39, 0x40000
    s_cbranch_scc1 L_decfin_1
    buffer_load_dword v19, v31, s[24:27], 0 offen sc1
    s_waitcnt vmcnt(0)
    v_readfirstlane_b32 s40, v19
    s_nop 3
    s_branch L_decslow_1
L_decfin_1:
    s_cmp_lg_u32 s40, s41
    s_branch L_decback_1
L_hs_1:
    v_add_u32 v21, 131072, v14
    s_waitcnt vmcnt(0)
    buffer_store_dword v2, v21, s[28:31], 0 offen sc1
    v_xor_b32 v21, 0x80, v21
L_hsp_1:
    buffer_load_dword v19, v21, s[28:31], 0 offen sc1
    v_add_u32 v17, 1, v17
    v_cmp_lt_u32 vcc, 0x80000, v17
    s_waitcnt vmcnt(0)
    s_cbranch_vccnz L_hsback_1
    v_cmp_eq_u32 vcc, -1, v19
    s_cbranch_vccnz L_hsp_1
    s_branch L_hsback_1
L_ps_1:
    buffer_store_dword v24, v14, s[28:31], 0 offen sc1
    s_branch L_psback_1
L_cons:
    s_load_dwordx2 s[20:21], s[0:1], 32
    s_load_dwordx2 s[28:29], s[0:1], 48
    s_load_dwordx2 s[24:25], s[0:1], 40
    s_add_u32 s22, s34, 1
    s_mul_i32 s22, s22, 1020416
    s_mov_b32 s23, 0x20000
    s_mov_b32 s30, 2359296
    s_mov_b32 s31, 0x20000
    s_and_b32 s38, s2, 7
    v_and_b32 v4, 31, v0
    v_lshrrev_b32 v7, 5, v0
    v_mul_u32_u24 v3, 272, v4
    v_lshl_add_u32 v3, v7, 4, v3
    v_add_u32 v3, 18496, v3
    v_lshrrev_b32 v1, 2, v7
    v_and_b32 v7, 3, v7
    v_lshl_add_u32 v7, v1, 5, v7
    v_lshlrev_b32 v7, 9, v7
    v_lshl_add_u32 v7, v4, 2, v7
    s_mul_i32 s37, s34, 1993
    s_lshl_b32 s39, s32, 6
    s_add_u32 s37, s37, s39
    s_mul_i32 s39, s35, 60
    s_sub_u32 s37, s37, s39
    s_lshl_b32 s37, s37, 9
    s_lshl_b32 s39, s33, 7
    s_add_u32 s37, s37, s39
    v_add_u32 v7, s37, v7
    v_lshlrev_b32 v4, 4, v4
    v_add_u32 v4, 35968, v4
    s_mov_b32 s56, 0x3eeff558
    s_mov_b32 s57, 0x409d30fc
    s_movk_i32 s26, 256
    s_mov_b32 s27, 0x20000
    s_lshl_b32 s37, s38, 5
    v_mov_b32 v31, s37
    s_lshl_b32 s37, s3, 2
    s_add_u32 s37, s37, 153792
    v_mov_b32 v18, s37
    s_getreg_b32 s41, hwreg(HW_REG_XCC_ID, 0, 4)
    s_mul_i32 s37, s41, s41
    s_lshl_b32 s37, s37, 10
    s_add_u32 s41, s41, s37
    s_lshl_b32 s41, s41, 8
    s_add_u32 s41, s41, 1
    s_lshl_b32 s41, s41, 5
    v_mov_b32 v10, v5
    v_lshrrev_b32 v11, 1, v10
    v_mul_u32_u24 v11, 1088, v11
    v_and_b32 v10, 1, v10
    v_lshl_add_u32 v11, v10, 9, v11
    v_lshlrev_b32 v10, 1, v10
    v_xor_b32 v10, v10, v6
    v_lshl_add_u32 v8, v10, 4, v11
    v_add_u32 v10, 1, v5
    v_lshrrev_b32 v11, 1, v10
    v_mul_u32_u24 v11, 1088, v11
    v_and_b32 v10, 1, v10
    v_lshl_add_u32 v11, v10, 9, v11
    v_lshlrev_b32 v10, 1, v10
    v_xor_b32 v10, v10, v6
    v_lshl_add_u32 v9, v10, 4, v11
    v_cmp_eq_u32 vcc, 15, v5
    v_add_u32 v28, 9728, v9
    v_add_u32 v10, 512, v9
    v_cndmask_b32 v28, v28, v10, vcc
    v_bfe_u32 v10, v2, 2, 2
    v_and_b32 v11, 3, v2
    v_lshlrev_b32 v11, 3, v11
    s_lshl_b32 s37, s3, 5
    v_add_u32 v11, s37, v11
    v_and_b32 v17, 2, v10
    v_lshlrev_b32 v17, 4, v17
    v_xor_b32 v11, v11, v17
    v_and_b32 v17, 1, v6
    v_lshlrev_b32 v13, 6, v17
    v_xor_b32 v11, v11, v13
    v_lshl_add_u32 v11, v10, 7, v11
    v_lshl_add_u32 v11, v6, 10, v11
    v_add_u32 v12, 55488, v11
    v_add_u32 v13, 121024, v11
    s_lshl_b32 s37, s38, 2
    s_add_u32 s37, s37, s3
    s_lshl_b32 s48, s37, 12
    s_lshl_b32 s37, s32, 7
    s_add_u32 s48, s48, s37
    v_lshlrev_b32 v14, 3, v5
    v_lshl_add_u32 v14, v17, 2, v14
    v_add_u32 v14, s48, v14
    v_lshlrev_b32 v10, 30, v6
    v_and_b32 v10, 0x80000000, v10
    v_or_b32 v14, v14, v10
    v_and_b32 v23, 0x7f, v14
    s_lshl_b32 s37, s3, 7
    s_add_u32 s37, s37, 153808
    v_add_u32 v23, s37, v23
    v_lshrrev_b32 v10, 2, v5
    v_cmp_eq_u32 vcc, v10, v6
    v_and_b32 v10, 1, v5
    v_lshlrev_b32 v10, 4, v10
    v_mov_b32 v11, 0x3f80
    v_lshlrev_b32 v11, v10, v11
    v_cndmask_b32 v11, 0, v11, vcc
    v_and_b32 v10, 2, v5
    v_cmp_eq_u32 vcc, 0, v10
    v_mov_b32 v248, 0
    v_mov_b32 v249, 0
    v_mov_b32 v252, 0
    v_mov_b32 v253, 0
    v_cndmask_b32 v250, 0, v11, vcc
    v_sub_u32 v251, v11, v250
    s_lshl_b32 s37, s2, 2
    s_add_u32 s37, s37, s3
    s_lshl_b32 s37, s37, 11
    s_add_u32 s37, s37, 262144
    v_lshl_add_u32 v20, v2, 4, s37
    v_xor_b32 v22, 0x10000, v20
    v_lshrrev_b32 v10, 1, v5
    s_lshl_b32 s37, s3, 3
    v_add_u32 v10, s37, v10
    v_mul_u32_u24 v15, 272, v10
    v_and_b32 v10, 1, v5
    v_mul_u32_u24 v10, 8768, v10
    v_lshl_add_u32 v10, v6, 6, v10
    v_add_u32 v10, 18496, v10
    v_add_u32 v15, v15, v10
    s_mov_b32 s51, 1
    s_mov_b32 s39, 0
    v_mov_b32 v17, 0
    s_cmp_ge_u32 s32, 30
    s_cselect_b32 s37, 2, 4
    v_cmp_ne_u32 vcc, s37, v6
    s_cmp_eq_u32 s35, 1
    s_nop 0
    v_cndmask_b32 v16, 0, 1.0, vcc
    s_waitcnt lgkmcnt(0)
    s_branch L_loop
.p2align 12
L_loop:
    s_setprio 2
    s_barrier
    ds_read_b128 v[64:67], v8 offset:0
    ds_read_b64_tr_b16 v[68:69], v12 offset:0
    ds_read_b64_tr_b16 v[70:71], v12 offset:512
    ds_read_b128 v[72:75], v8 offset:64
    ds_read_b64_tr_b16 v[76:77], v12 offset:4096
    ds_read_b64_tr_b16 v[78:79], v12 offset:4608
    ds_read_b128 v[80:83], v8 offset:192
    ds_read_b128 v[84:87], v8 offset:128
    ds_read_b128 v[88:91], v8 offset:256
    ds_read_b128 v[92:95], v8 offset:320
    s_waitcnt lgkmcnt(7)
    v_mfma_f32_16x16x32_bf16 v[32:35], v[64:67], v[68:71], 0
    ds_read_b128 v[96:99], v8 offset:448
    s_waitcnt lgkmcnt(5)
    v_mfma_f32_16x16x32_bf16 v[32:35], v[72:75], v[76:79], v[32:35]
    ds_read_b128 v[100:103], v8 offset:384
    s_waitcnt lgkmcnt(5)
    v_mfma_f32_16x16x32_bf16 v[36:39], v[80:83], v[76:79], 0
    s_waitcnt lgkmcnt(2)
    v_mfma_f32_16x16x32_bf16 v[36:39], v[84:87], v[68:71], v[36:39]
    s_barrier
    v_mfma_f32_16x16x32_bf16 v[40:43], v[88:91], v[68:71], 0
    ds_read_b128 v[104:107], v8 offset:9920
    ds_read_b128 v[108:111], v8 offset:9792
    ds_read_b128 v[112:115], v8 offset:9728
    v_mfma_f32_16x16x32_bf16 v[40:43], v[92:95], v[76:79], v[40:43]
    ds_read_b128 v[116:119], v8 offset:9856
    s_barrier
    s_waitcnt lgkmcnt(4)
    v_mfma_f32_16x16x32_bf16 v[44:47], v[96:99], v[76:79], 0
    ds_read_b128 v[120:123], v8 offset:9984
    v_mfma_f32_16x16x32_bf16 v[44:47], v[100:103], v[68:71], v[44:47]
    ds_read_b128 v[124:127], v8 offset:10048
    s_waitcnt lgkmcnt(3)
    v_mfma_f32_16x16x32_bf16 v[48:51], v[112:115], v[68:71], 0
    ds_read_b128 v[128:131], v8 offset:10176
    ds_read_b128 v[132:135], v8 offset:10112
    v_mfma_f32_16x16x32_bf16 v[48:51], v[108:111], v[76:79], v[48:51]
    ds_read_b64_tr_b16 v[136:137], v12 offset:8192
    ds_read_b64_tr_b16 v[138:139], v12 offset:8704
    v_mfma_f32_16x16x32_bf16 v[52:55], v[104:107], v[76:79], 0
    ds_read_b64_tr_b16 v[140:141], v12 offset:12288
    s_waitcnt lgkmcnt(5)
    v_mfma_f32_16x16x32_bf16 v[52:55], v[116:119], v[68:71], v[52:55]
    ds_read_b64_tr_b16 v[142:143], v12 offset:12800
    v_mfma_f32_16x16x32_bf16 v[56:59], v[120:123], v[68:71], 0
    v_mfma_f32_16x16x32_bf16 v[56:59], v[124:127], v[76:79], v[56:59]
    s_waitcnt lgkmcnt(2)
    v_mfma_f32_16x16x32_bf16 v[60:63], v[128:131], v[76:79], 0
    v_mfma_f32_16x16x32_bf16 v[60:63], v[132:135], v[68:71], v[60:63]
    v_mfma_f32_16x16x32_bf16 v[32:35], v[84:87], v[136:139], v[32:35]
    s_waitcnt lgkmcnt(0)
    v_mfma_f32_16x16x32_bf16 v[32:35], v[80:83], v[140:143], v[32:35]
    v_mfma_f32_16x16x32_bf16 v[36:39], v[92:95], v[140:143], v[36:39]
    v_mfma_f32_16x16x32_bf16 v[36:39], v[88:91], v[136:139], v[36:39]
    v_mfma_f32_16x16x32_bf16 v[40:43], v[100:103], v[136:139], v[40:43]
    v_mfma_f32_16x16x32_bf16 v[40:43], v[96:99], v[140:143], v[40:43]
    s_barrier
    v_mfma_f32_16x16x32_bf16 v[44:47], v[108:111], v[140:143], v[44:47]
    ds_read_b128 v[144:147], v9 offset:64
    v_mfma_f32_16x16x32_bf16 v[44:47], v[112:115], v[136:139], v[44:47]
    ds_read_b128 v[148:151], v9 offset:0
    v_mfma_f32_16x16x32_bf16 v[48:51], v[116:119], v[136:139], v[48:51]
    ds_read_b64_tr_b16 v[152:153], v12 offset:16384
    v_mfma_f32_16x16x32_bf16 v[48:51], v[104:107], v[140:143], v[48:51]
    ds_read_b64_tr_b16 v[154:155], v12 offset:16896
    v_mfma_f32_16x16x32_bf16 v[52:55], v[124:127], v[140:143], v[52:55]
    ds_read_b64_tr_b16 v[156:157], v12 offset:20480
    v_mfma_f32_16x16x32_bf16 v[52:55], v[120:123], v[136:139], v[52:55]
    ds_read_b64_tr_b16 v[158:159], v12 offset:20992
    v_mfma_f32_16x16x32_bf16 v[56:59], v[132:135], v[136:139], v[56:59]
    v_mfma_f32_16x16x32_bf16 v[56:59], v[128:131], v[140:143], v[56:59]
    s_waitcnt lgkmcnt(2)
    v_mfma_f32_16x16x32_bf16 v[60:63], v[144:147], v[140:143], v[60:63]
    v_mfma_f32_16x16x32_bf16 v[60:63], v[148:151], v[136:139], v[60:63]
    v_mfma_f32_16x16x32_bf16 v[32:35], v[88:91], v[152:155], v[32:35]
    s_waitcnt lgkmcnt(0)
    v_mfma_f32_16x16x32_bf16 v[32:35], v[92:95], v[156:159], v[32:35]
    v_mfma_f32_16x16x32_bf16 v[36:39], v[96:99], v[156:159], v[36:39]
    v_mfma_f32_16x16x32_bf16 v[36:39], v[100:103], v[152:155], v[36:39]
    v_mfma_f32_16x16x32_bf16 v[40:43], v[112:115], v[152:155], v[40:43]
    v_mfma_f32_16x16x32_bf16 v[40:43], v[108:111], v[156:159], v[40:43]
    s_barrier
    v_mfma_f32_16x16x32_bf16 v[44:47], v[104:107], v[156:159], v[44:47]
    ds_read_b128 v[160:163], v9 offset:192
    v_mfma_f32_16x16x32_bf16 v[44:47], v[116:119], v[152:155], v[44:47]
    ds_read_b128 v[164:167], v9 offset:128
    v_mfma_f32_16x16x32_bf16 v[48:51], v[120:123], v[152:155], v[48:51]
    ds_read_b64_tr_b16 v[168:169], v12 offset:24576
    v_mfma_f32_16x16x32_bf16 v[48:51], v[124:127], v[156:159], v[48:51]
    ds_read_b64_tr_b16 v[170:171], v12 offset:25088
    v_mfma_f32_16x16x32_bf16 v[52:55], v[128:131], v[156:159], v[52:55]
    ds_read_b64_tr_b16 v[172:173], v12 offset:28672
    v_mfma_f32_16x16x32_bf16 v[52:55], v[132:135], v[152:155], v[52:55]
    ds_read_b64_tr_b16 v[174:175], v12 offset:29184
    v_mfma_f32_16x16x32_bf16 v[56:59], v[148:151], v[152:155], v[56:59]
    v_mfma_f32_16x16x32_bf16 v[56:59], v[144:147], v[156:159], v[56:59]
    s_waitcnt lgkmcnt(2)
    v_mfma_f32_16x16x32_bf16 v[60:63], v[160:163], v[156:159], v[60:63]
    v_mfma_f32_16x16x32_bf16 v[60:63], v[164:167], v[152:155], v[60:63]
    v_mfma_f32_16x16x32_bf16 v[32:35], v[100:103], v[168:171], v[32:35]
    s_waitcnt lgkmcnt(0)
    v_mfma_f32_16x16x32_bf16 v[32:35], v[96:99], v[172:175], v[32:35]
    v_mfma_f32_16x16x32_bf16 v[36:39], v[108:111], v[172:175], v[36:39]
    v_mfma_f32_16x16x32_bf16 v[36:39], v[112:115], v[168:171], v[36:39]
    v_mfma_f32_16x16x32_bf16 v[40:43], v[116:119], v[168:171], v[40:43]
    v_mfma_f32_16x16x32_bf16 v[40:43], v[104:107], v[172:175], v[40:43]
    s_barrier
    v_mfma_f32_16x16x32_bf16 v[44:47], v[124:127], v[172:175], v[44:47]
    ds_read_b128 v[176:179], v9 offset:320
    v_mfma_f32_16x16x32_bf16 v[44:47], v[120:123], v[168:171], v[44:47]
    ds_read_b128 v[180:183], v9 offset:256
    v_mfma_f32_16x16x32_bf16 v[48:51], v[132:135], v[168:171], v[48:51]
    ds_read_b64_tr_b16 v[184:185], v12 offset:32768
    v_mfma_f32_16x16x32_bf16 v[48:51], v[128:131], v[172:175], v[48:51]
    ds_read_b64_tr_b16 v[186:187], v12 offset:33280
    v_mfma_f32_16x16x32_bf16 v[52:55], v[144:147], v[172:175], v[52:55]
    ds_read_b64_tr_b16 v[188:189], v12 offset:36864
    v_mfma_f32_16x16x32_bf16 v[52:55], v[148:151], v[168:171], v[52:55]
    ds_read_b64_tr_b16 v[190:191], v12 offset:37376
    v_mfma_f32_16x16x32_bf16 v[56:59], v[164:167], v[168:171], v[56:59]
    v_mfma_f32_16x16x32_bf16 v[56:59], v[160:163], v[172:175], v[56:59]
    s_waitcnt lgkmcnt(2)
    v_mfma_f32_16x16x32_bf16 v[60:63], v[176:179], v[172:175], v[60:63]
    v_mfma_f32_16x16x32_bf16 v[60:63], v[180:183], v[168:171], v[60:63]
    v_mfma_f32_16x16x32_bf16 v[32:35], v[112:115], v[184:187], v[32:35]
    s_waitcnt lgkmcnt(0)
    v_mfma_f32_16x16x32_bf16 v[32:35], v[108:111], v[188:191], v[32:35]
    v_mfma_f32_16x16x32_bf16 v[36:39], v[104:107], v[188:191], v[36:39]
    v_mfma_f32_16x16x32_bf16 v[36:39], v[116:119], v[184:187], v[36:39]
    v_mfma_f32_16x16x32_bf16 v[40:43], v[120:123], v[184:187], v[40:43]
    v_mfma_f32_16x16x32_bf16 v[40:43], v[124:127], v[188:191], v[40:43]
    s_barrier
    v_mfma_f32_16x16x32_bf16 v[44:47], v[128:131], v[188:191], v[44:47]
    ds_read_b128 v[192:195], v9 offset:448
    v_mfma_f32_16x16x32_bf16 v[44:47], v[132:135], v[184:187], v[44:47]
    ds_read_b128 v[196:199], v9 offset:384
    v_mfma_f32_16x16x32_bf16 v[48:51], v[148:151], v[184:187], v[48:51]
    ds_read_b64_tr_b16 v[200:201], v12 offset:40960
    v_mfma_f32_16x16x32_bf16 v[48:51], v[144:147], v[188:191], v[48:51]
    ds_read_b64_tr_b16 v[202:203], v12 offset:41472
    v_mfma_f32_16x16x32_bf16 v[52:55], v[160:163], v[188:191], v[52:55]
    ds_read_b64_tr_b16 v[204:205], v12 offset:45056
    v_mfma_f32_16x16x32_bf16 v[52:55], v[164:167], v[184:187], v[52:55]
    ds_read_b64_tr_b16 v[206:207], v12 offset:45568
    v_mfma_f32_16x16x32_bf16 v[56:59], v[180:183], v[184:187], v[56:59]
    v_mfma_f32_16x16x32_bf16 v[56:59], v[176:179], v[188:191], v[56:59]
    s_waitcnt lgkmcnt(2)
    v_mfma_f32_16x16x32_bf16 v[60:63], v[192:195], v[188:191], v[60:63]
    v_mfma_f32_16x16x32_bf16 v[60:63], v[196:199], v[184:187], v[60:63]
    v_mfma_f32_16x16x32_bf16 v[32:35], v[116:119], v[200:203], v[32:35]
    s_waitcnt lgkmcnt(0)
    v_mfma_f32_16x16x32_bf16 v[32:35], v[104:107], v[204:207], v[32:35]
    v_mfma_f32_16x16x32_bf16 v[36:39], v[124:127], v[204:207], v[36:39]
    v_mfma_f32_16x16x32_bf16 v[36:39], v[120:123], v[200:203], v[36:39]
    v_mfma_f32_16x16x32_bf16 v[40:43], v[132:135], v[200:203], v[40:43]
    v_mfma_f32_16x16x32_bf16 v[40:43], v[128:131], v[204:207], v[40:43]
    s_barrier
    v_mfma_f32_16x16x32_bf16 v[44:47], v[144:147], v[204:207], v[44:47]
    ds_read_b128 v[208:211], v28 offset:64
    v_mfma_f32_16x16x32_bf16 v[44:47], v[148:151], v[200:203], v[44:47]
    ds_read_b128 v[212:215], v28 offset:0
    v_mfma_f32_16x16x32_bf16 v[48:51], v[164:167], v[200:203], v[48:51]
    ds_read_b64_tr_b16 v[216:217], v12 offset:49152
    v_mfma_f32_16x16x32_bf16 v[48:51], v[160:163], v[204:207], v[48:51]
    ds_read_b64_tr_b16 v[218:219], v12 offset:49664
    v_mfma_f32_16x16x32_bf16 v[52:55], v[176:179], v[204:207], v[52:55]
    ds_read_b64_tr_b16 v[220:221], v12 offset:53248
    v_mfma_f32_16x16x32_bf16 v[52:55], v[180:183], v[200:203], v[52:55]
    ds_read_b64_tr_b16 v[222:223], v12 offset:53760
    v_mfma_f32_16x16x32_bf16 v[56:59], v[196:199], v[200:203], v[56:59]
    v_mfma_f32_16x16x32_bf16 v[56:59], v[192:195], v[204:207], v[56:59]
    s_waitcnt lgkmcnt(2)
    v_mfma_f32_16x16x32_bf16 v[60:63], v[208:211], v[204:207], v[60:63]
    v_mfma_f32_16x16x32_bf16 v[60:63], v[212:215], v[200:203], v[60:63]
    v_mfma_f32_16x16x32_bf16 v[32:35], v[120:123], v[216:219], v[32:35]
    s_waitcnt lgkmcnt(0)
    v_mfma_f32_16x16x32_bf16 v[32:35], v[124:127], v[220:223], v[32:35]
    v_mfma_f32_16x16x32_bf16 v[36:39], v[128:131], v[220:223], v[36:39]
    v_mfma_f32_16x16x32_bf16 v[36:39], v[132:135], v[216:219], v[36:39]
    v_mfma_f32_16x16x32_bf16 v[40:43], v[148:151], v[216:219], v[40:43]
    v_mfma_f32_16x16x32_bf16 v[40:43], v[144:147], v[220:223], v[40:43]
    s_barrier
    v_mfma_f32_16x16x32_bf16 v[44:47], v[160:163], v[220:223], v[44:47]
    ds_read_b128 v[224:227], v28 offset:192
    v_mfma_f32_16x16x32_bf16 v[44:47], v[164:167], v[216:219], v[44:47]
    ds_read_b128 v[228:231], v28 offset:128
    v_mfma_f32_16x16x32_bf16 v[48:51], v[180:183], v[216:219], v[48:51]
    ds_read_b64_tr_b16 v[232:233], v12 offset:57344
    v_mfma_f32_16x16x32_bf16 v[48:51], v[176:179], v[220:223], v[48:51]
    ds_read_b64_tr_b16 v[234:235], v12 offset:57856
    v_mfma_f32_16x16x32_bf16 v[52:55], v[192:195], v[220:223], v[52:55]
    ds_read_b64_tr_b16 v[236:237], v12 offset:61440
    v_mfma_f32_16x16x32_bf16 v[52:55], v[196:199], v[216:219], v[52:55]
    ds_read_b64_tr_b16 v[238:239], v12 offset:61952
    v_mfma_f32_16x16x32_bf16 v[56:59], v[212:215], v[216:219], v[56:59]
    v_mfma_f32_16x16x32_bf16 v[56:59], v[208:211], v[220:223], v[56:59]
    s_waitcnt lgkmcnt(2)
    v_mfma_f32_16x16x32_bf16 v[60:63], v[224:227], v[220:223], v[60:63]
    v_mfma_f32_16x16x32_bf16 v[60:63], v[228:231], v[216:219], v[60:63]
    v_mfma_f32_16x16x32_bf16 v[32:35], v[132:135], v[232:235], v[32:35]
    s_waitcnt lgkmcnt(0)
    v_mfma_f32_16x16x32_bf16 v[32:35], v[128:131], v[236:239], v[32:35]
    v_mfma_f32_16x16x32_bf16 v[36:39], v[144:147], v[236:239], v[36:39]
    ds_read_b128 v[240:243], v8 offset:18496
    v_mfma_f32_16x16x32_bf16 v[36:39], v[148:151], v[232:235], v[36:39]
    ds_read_b128 v[244:247], v8 offset:18560
    v_mfma_f32_16x16x32_bf16 v[40:43], v[164:167], v[232:235], v[40:43]
    ds_read_b128 v[64:67], v8 offset:18688
    v_mfma_f32_16x16x32_bf16 v[40:43], v[160:163], v[236:239], v[40:43]
    ds_read_b128 v[72:75], v8 offset:18624
    v_mfma_f32_16x16x32_bf16 v[44:47], v[176:179], v[236:239], v[44:47]
    ds_read_b128 v[76:79], v28 offset:320
    v_mfma_f32_16x16x32_bf16 v[44:47], v[180:183], v[232:235], v[44:47]
    ds_read_b128 v[68:71], v28 offset:256
    v_mfma_f32_16x16x32_bf16 v[48:51], v[196:199], v[232:235], v[48:51]
    ds_read_b64_tr_b16 v[84:85], v13 offset:0
    v_mfma_f32_16x16x32_bf16 v[48:51], v[192:195], v[236:239], v[48:51]
    ds_read_b64_tr_b16 v[86:87], v13 offset:512
    v_mfma_f32_16x16x32_bf16 v[52:55], v[208:211], v[236:239], v[52:55]
    ds_read_b64_tr_b16 v[80:81], v13 offset:4096
    v_mfma_f32_16x16x32_bf16 v[52:55], v[212:215], v[232:235], v[52:55]
    ds_read_b64_tr_b16 v[82:83], v13 offset:4608
    v_mfma_f32_16x16x32_bf16 v[56:59], v[228:231], v[232:235], v[56:59]
    ds_read_b128 v[140:143], v8 offset:18752
    v_mfma_f32_16x16x32_bf16 v[56:59], v[224:227], v[236:239], v[56:59]
    ds_read_b128 v[136:139], v8 offset:18816
    s_waitcnt lgkmcnt(4)
    v_mfma_f32_16x16x32_bf16 v[60:63], v[76:79], v[236:239], v[60:63]
    ds_read_b128 v[88:91], v8 offset:18944
    v_mfma_f32_16x16x32_bf16 v[60:63], v[68:71], v[232:235], v[60:63]
    ds_read_b128 v[92:95], v8 offset:18880
    v_mfma_f32_16x16x32_bf16 v[32:35], v[240:243], v[84:87], v[32:35]
    ds_read_b128 v[156:159], v8 offset:28224
    s_waitcnt lgkmcnt(5)
    v_mfma_f32_16x16x32_bf16 v[32:35], v[244:247], v[80:83], v[32:35]
    ds_read_b128 v[152:155], v8 offset:28288
    v_mfma_f32_16x16x32_bf16 v[36:39], v[64:67], v[80:83], v[36:39]
    ds_read_b128 v[100:103], v8 offset:28416
    v_mfma_f32_16x16x32_bf16 v[36:39], v[72:75], v[84:87], v[36:39]
    ds_read_b128 v[96:99], v8 offset:28352
    s_waitcnt lgkmcnt(5)
    v_mfma_f32_16x16x32_bf16 v[40:43], v[140:143], v[84:87], v[40:43]
    ds_read_b128 v[172:175], v8 offset:28480
    v_mfma_f32_16x16x32_bf16 v[40:43], v[136:139], v[80:83], v[40:43]
    ds_read_b128 v[168:171], v8 offset:28544
    s_barrier
    v_mfma_f32_16x16x32_bf16 v[44:47], v[88:91], v[80:83], v[44:47]
    ds_read_b128 v[112:115], v8 offset:28672
    s_waitcnt lgkmcnt(5)
    v_mfma_f32_16x16x32_bf16 v[44:47], v[92:95], v[84:87], v[44:47]
    ds_read_b128 v[108:111], v8 offset:28608
    v_mfma_f32_16x16x32_bf16 v[48:51], v[156:159], v[84:87], v[48:51]
    ds_read_b64_tr_b16 v[188:189], v13 offset:8192
    v_mfma_f32_16x16x32_bf16 v[48:51], v[152:155], v[80:83], v[48:51]
    ds_read_b64_tr_b16 v[190:191], v13 offset:8704
    s_waitcnt lgkmcnt(5)
    v_mfma_f32_16x16x32_bf16 v[52:55], v[100:103], v[80:83], v[52:55]
    ds_read_b64_tr_b16 v[184:185], v13 offset:12288
    v_mfma_f32_16x16x32_bf16 v[52:55], v[96:99], v[84:87], v[52:55]
    ds_read_b64_tr_b16 v[186:187], v13 offset:12800
    v_mfma_f32_16x16x32_bf16 v[56:59], v[172:175], v[84:87], v[56:59]
    s_waitcnt lgkmcnt(4)
    v_mfma_f32_16x16x32_bf16 v[56:59], v[168:171], v[80:83], v[56:59]
    v_mfma_f32_16x16x32_bf16 v[60:63], v[112:115], v[80:83], v[60:63]
    v_mfma_f32_16x16x32_bf16 v[60:63], v[108:111], v[84:87], v[60:63]
    s_waitcnt lgkmcnt(0)
    v_mfma_f32_16x16x32_bf16 v[32:35], v[72:75], v[188:191], v[32:35]
    v_mfma_f32_16x16x32_bf16 v[32:35], v[64:67], v[184:187], v[32:35]
    v_mfma_f32_16x16x32_bf16 v[36:39], v[136:139], v[184:187], v[36:39]
    v_mfma_f32_16x16x32_bf16 v[36:39], v[140:143], v[188:191], v[36:39]
    v_mfma_f32_16x16x32_bf16 v[40:43], v[92:95], v[188:191], v[40:43]
    v_mfma_f32_16x16x32_bf16 v[40:43], v[88:91], v[184:187], v[40:43]
    v_mfma_f32_16x16x32_bf16 v[44:47], v[152:155], v[184:187], v[44:47]
    ds_read_b128 v[116:119], v9 offset:18560
    v_mfma_f32_16x16x32_bf16 v[44:47], v[156:159], v[188:191], v[44:47]
    ds_read_b128 v[104:107], v9 offset:18496
    v_mfma_f32_16x16x32_bf16 v[48:51], v[96:99], v[188:191], v[48:51]
    ds_read_b64_tr_b16 v[204:205], v13 offset:16384
    v_mfma_f32_16x16x32_bf16 v[48:51], v[100:103], v[184:187], v[48:51]
    ds_read_b64_tr_b16 v[206:207], v13 offset:16896
    v_mfma_f32_16x16x32_bf16 v[52:55], v[168:171], v[184:187], v[52:55]
    ds_read_b64_tr_b16 v[200:201], v13 offset:20480
    v_mfma_f32_16x16x32_bf16 v[52:55], v[172:175], v[188:191], v[52:55]
    ds_read_b64_tr_b16 v[202:203], v13 offset:20992
    v_mfma_f32_16x16x32_bf16 v[56:59], v[108:111], v[188:191], v[56:59]
    v_mfma_f32_16x16x32_bf16 v[56:59], v[112:115], v[184:187], v[56:59]
    s_waitcnt lgkmcnt(2)
    v_mfma_f32_16x16x32_bf16 v[60:63], v[116:119], v[184:187], v[60:63]
    v_mfma_f32_16x16x32_bf16 v[60:63], v[104:107], v[188:191], v[60:63]
    v_mfma_f32_16x16x32_bf16 v[32:35], v[140:143], v[204:207], v[32:35]
    s_waitcnt lgkmcnt(0)
    v_mfma_f32_16x16x32_bf16 v[32:35], v[136:139], v[200:203], v[32:35]
    v_mfma_f32_16x16x32_bf16 v[36:39], v[88:91], v[200:203], v[36:39]
    v_mfma_f32_16x16x32_bf16 v[36:39], v[92:95], v[204:207], v[36:39]
    v_mfma_f32_16x16x32_bf16 v[40:43], v[156:159], v[204:207], v[40:43]
    v_mfma_f32_16x16x32_bf16 v[40:43], v[152:155], v[200:203], v[40:43]
    v_mfma_f32_16x16x32_bf16 v[44:47], v[100:103], v[200:203], v[44:47]
    ds_read_b128 v[120:123], v9 offset:18688
    v_mfma_f32_16x16x32_bf16 v[44:47], v[96:99], v[204:207], v[44:47]
    ds_read_b128 v[124:127], v9 offset:18624
    v_mfma_f32_16x16x32_bf16 v[48:51], v[172:175], v[204:207], v[48:51]
    ds_read_b64_tr_b16 v[220:221], v13 offset:24576
    v_mfma_f32_16x16x32_bf16 v[48:51], v[168:171], v[200:203], v[48:51]
    ds_read_b64_tr_b16 v[222:223], v13 offset:25088
    v_mfma_f32_16x16x32_bf16 v[52:55], v[112:115], v[200:203], v[52:55]
    ds_read_b64_tr_b16 v[216:217], v13 offset:28672
    v_mfma_f32_16x16x32_bf16 v[52:55], v[108:111], v[204:207], v[52:55]
    ds_read_b64_tr_b16 v[218:219], v13 offset:29184
    v_mfma_f32_16x16x32_bf16 v[56:59], v[104:107], v[204:207], v[56:59]
    v_mfma_f32_16x16x32_bf16 v[56:59], v[116:119], v[200:203], v[56:59]
    s_waitcnt lgkmcnt(2)
    v_mfma_f32_16x16x32_bf16 v[60:63], v[120:123], v[200:203], v[60:63]
    v_mfma_f32_16x16x32_bf16 v[60:63], v[124:127], v[204:207], v[60:63]
    v_mfma_f32_16x16x32_bf16 v[32:35], v[92:95], v[220:223], v[32:35]
    s_waitcnt lgkmcnt(0)
    v_mfma_f32_16x16x32_bf16 v[32:35], v[88:91], v[216:219], v[32:35]
    v_mfma_f32_16x16x32_bf16 v[36:39], v[152:155], v[216:219], v[36:39]
    v_mfma_f32_16x16x32_bf16 v[36:39], v[156:159], v[220:223], v[36:39]
    v_mfma_f32_16x16x32_bf16 v[40:43], v[96:99], v[220:223], v[40:43]
    v_mfma_f32_16x16x32_bf16 v[40:43], v[100:103], v[216:219], v[40:43]
    v_mfma_f32_16x16x32_bf16 v[44:47], v[168:171], v[216:219], v[44:47]
    ds_read_b128 v[132:135], v9 offset:18816
    v_mfma_f32_16x16x32_bf16 v[44:47], v[172:175], v[220:223], v[44:47]
    ds_read_b128 v[128:131], v9 offset:18752
    v_mfma_f32_16x16x32_bf16 v[48:51], v[108:111], v[220:223], v[48:51]
    ds_read_b64_tr_b16 v[144:145], v12 offset:0
    v_mfma_f32_16x16x32_bf16 v[48:51], v[112:115], v[216:219], v[48:51]
    ds_read_b64_tr_b16 v[146:147], v12 offset:512
    v_mfma_f32_16x16x32_bf16 v[52:55], v[116:119], v[216:219], v[52:55]
    ds_read_b64_tr_b16 v[148:149], v12 offset:4096
    v_mfma_f32_16x16x32_bf16 v[52:55], v[104:107], v[220:223], v[52:55]
    ds_read_b64_tr_b16 v[150:151], v12 offset:4608
    v_mfma_f32_16x16x32_bf16 v[56:59], v[124:127], v[220:223], v[56:59]
    v_mfma_f32_16x16x32_bf16 v[56:59], v[120:123], v[216:219], v[56:59]
    s_waitcnt lgkmcnt(2)
    v_mfma_f32_16x16x32_bf16 v[60:63], v[132:135], v[216:219], v[60:63]
    v_mfma_f32_16x16x32_bf16 v[60:63], v[128:131], v[220:223], v[60:63]
    v_mfma_f32_16x16x32_bf16 v[32:35], v[156:159], v[144:147], v[32:35]
    s_waitcnt lgkmcnt(0)
    v_mfma_f32_16x16x32_bf16 v[32:35], v[152:155], v[148:151], v[32:35]
    v_mfma_f32_16x16x32_bf16 v[36:39], v[100:103], v[148:151], v[36:39]
    v_mfma_f32_16x16x32_bf16 v[36:39], v[96:99], v[144:147], v[36:39]
    v_mfma_f32_16x16x32_bf16 v[40:43], v[172:175], v[144:147], v[40:43]
    v_mfma_f32_16x16x32_bf16 v[40:43], v[168:171], v[148:151], v[40:43]
    s_barrier
    v_mfma_f32_16x16x32_bf16 v[44:47], v[112:115], v[148:151], v[44:47]
    ds_read_b128 v[164:167], v9 offset:18944
    v_mfma_f32_16x16x32_bf16 v[44:47], v[108:111], v[144:147], v[44:47]
    ds_read_b128 v[160:163], v9 offset:18880
    v_mfma_f32_16x16x32_bf16 v[48:51], v[104:107], v[144:147], v[48:51]
    ds_read_b64_tr_b16 v[176:177], v12 offset:8192
    v_mfma_f32_16x16x32_bf16 v[48:51], v[116:119], v[148:151], v[48:51]
    ds_read_b64_tr_b16 v[178:179], v12 offset:8704
    v_mfma_f32_16x16x32_bf16 v[52:55], v[120:123], v[148:151], v[52:55]
    ds_read_b64_tr_b16 v[180:181], v12 offset:12288
    v_mfma_f32_16x16x32_bf16 v[52:55], v[124:127], v[144:147], v[52:55]
    ds_read_b64_tr_b16 v[182:183], v12 offset:12800
    v_mfma_f32_16x16x32_bf16 v[56:59], v[128:131], v[144:147], v[56:59]
    v_mfma_f32_16x16x32_bf16 v[56:59], v[132:135], v[148:151], v[56:59]
    s_waitcnt lgkmcnt(2)
    v_mfma_f32_16x16x32_bf16 v[60:63], v[164:167], v[148:151], v[60:63]
    v_mfma_f32_16x16x32_bf16 v[60:63], v[160:163], v[144:147], v[60:63]
    v_mfma_f32_16x16x32_bf16 v[32:35], v[96:99], v[176:179], v[32:35]
    s_waitcnt lgkmcnt(0)
    v_mfma_f32_16x16x32_bf16 v[32:35], v[100:103], v[180:183], v[32:35]
    v_mfma_f32_16x16x32_bf16 v[36:39], v[168:171], v[180:183], v[36:39]
    v_mfma_f32_16x16x32_bf16 v[36:39], v[172:175], v[176:179], v[36:39]
    v_mfma_f32_16x16x32_bf16 v[40:43], v[108:111], v[176:179], v[40:43]
    v_mfma_f32_16x16x32_bf16 v[40:43], v[112:115], v[180:183], v[40:43]
    s_barrier
    v_mfma_f32_16x16x32_bf16 v[44:47], v[116:119], v[180:183], v[44:47]
    ds_read_b128 v[196:199], v28 offset:18560
    v_mfma_f32_16x16x32_bf16 v[44:47], v[104:107], v[176:179], v[44:47]
    ds_read_b128 v[192:195], v28 offset:18496
    v_mfma_f32_16x16x32_bf16 v[48:51], v[124:127], v[176:179], v[48:51]
    ds_read_b64_tr_b16 v[208:209], v12 offset:16384
    v_mfma_f32_16x16x32_bf16 v[48:51], v[120:123], v[180:183], v[48:51]
    ds_read_b64_tr_b16 v[210:211], v12 offset:16896
    v_mfma_f32_16x16x32_bf16 v[52:55], v[132:135], v[180:183], v[52:55]
    ds_read_b64_tr_b16 v[212:213], v12 offset:20480
    v_mfma_f32_16x16x32_bf16 v[52:55], v[128:131], v[176:179], v[52:55]
    ds_read_b64_tr_b16 v[214:215], v12 offset:20992
    v_mfma_f32_16x16x32_bf16 v[56:59], v[160:163], v[176:179], v[56:59]
    v_mfma_f32_16x16x32_bf16 v[56:59], v[164:167], v[180:183], v[56:59]
    s_waitcnt lgkmcnt(2)
    v_mfma_f32_16x16x32_bf16 v[60:63], v[196:199], v[180:183], v[60:63]
    v_mfma_f32_16x16x32_bf16 v[60:63], v[192:195], v[176:179], v[60:63]
    v_mfma_f32_16x16x32_bf16 v[32:35], v[172:175], v[208:211], v[32:35]
    s_waitcnt lgkmcnt(0)
    v_mfma_f32_16x16x32_bf16 v[32:35], v[168:171], v[212:215], v[32:35]
    v_mfma_f32_16x16x32_bf16 v[36:39], v[112:115], v[212:215], v[36:39]
    ds_read_b128 v[228:231], v28 offset:18688
    s_cbranch_scc1 L_var1
    s_branch L_var0
.p2align 12
L_stub0:
    s_branch L_stubback
L_var0:
    s_barrier
    v_mfma_f32_16x16x32_bf16 v[36:39], v[108:111], v[208:211], v[36:39]
    ds_read_b128 v[224:227], v28 offset:18624
    v_mfma_f32_16x16x32_bf16 v[40:43], v[104:107], v[208:211], v[40:43]
    ds_read_b64_tr_b16 v[76:77], v12 offset:24576
    v_mfma_f32_16x16x32_bf16 v[40:43], v[116:119], v[212:215], v[40:43]
    ds_read_b128 v[236:239], v8 offset:36992
    v_mfma_f32_16x16x32_bf16 v[44:47], v[120:123], v[212:215], v[44:47]
    ds_read_b64_tr_b16 v[78:79], v12 offset:25088
    v_mfma_f32_16x16x32_bf16 v[44:47], v[124:127], v[208:211], v[44:47]
    ds_read_b64_tr_b16 v[68:69], v12 offset:28672
    v_mfma_f32_16x16x32_bf16 v[48:51], v[128:131], v[208:211], v[48:51]
    ds_read_b128 v[232:235], v8 offset:37056
    v_mfma_f32_16x16x32_bf16 v[48:51], v[132:135], v[212:215], v[48:51]
    ds_read_b64_tr_b16 v[70:71], v12 offset:29184
    v_mfma_f32_16x16x32_bf16 v[52:55], v[164:167], v[212:215], v[52:55]
    ds_read_b128 v[240:243], v8 offset:37184
    v_mfma_f32_16x16x32_bf16 v[52:55], v[160:163], v[208:211], v[52:55]
    ds_read_b128 v[244:247], v8 offset:37120
    v_mfma_f32_16x16x32_bf16 v[56:59], v[192:195], v[208:211], v[56:59]
    ds_read_b128 v[80:83], v8 offset:37248
    v_mfma_f32_16x16x32_bf16 v[56:59], v[196:199], v[212:215], v[56:59]
    ds_read_b128 v[84:87], v8 offset:37312
    s_waitcnt lgkmcnt(7)
    v_mfma_f32_16x16x32_bf16 v[60:63], v[228:231], v[212:215], v[60:63]
    ds_read_b128 v[72:75], v8 offset:37440
    v_mfma_f32_16x16x32_bf16 v[60:63], v[224:227], v[208:211], v[60:63]
    ds_read_b128 v[64:67], v8 offset:37376
    v_mfma_f32_16x16x32_bf16 v[32:35], v[236:239], v[76:79], v[32:35]
    ds_read_b128 v[184:187], v8 offset:46720
    s_waitcnt lgkmcnt(5)
    v_mfma_f32_16x16x32_bf16 v[32:35], v[232:235], v[68:71], v[32:35]
    ds_read_b128 v[188:191], v8 offset:46784
    v_mfma_f32_16x16x32_bf16 v[36:39], v[240:243], v[68:71], v[36:39]
    ds_read_b128 v[140:143], v8 offset:46912
    v_mfma_f32_16x16x32_bf16 v[36:39], v[244:247], v[76:79], v[36:39]
    ds_read_b128 v[136:139], v8 offset:46848
    s_waitcnt lgkmcnt(5)
    v_mfma_f32_16x16x32_bf16 v[40:43], v[80:83], v[76:79], v[40:43]
    ds_read_b128 v[200:203], v8 offset:46976
    v_mfma_f32_16x16x32_bf16 v[40:43], v[84:87], v[68:71], v[40:43]
    ds_read_b128 v[204:207], v8 offset:47040
    s_barrier
    v_mfma_f32_16x16x32_bf16 v[44:47], v[72:75], v[68:71], v[44:47]
    ds_read_b128 v[92:95], v8 offset:47168
    s_waitcnt lgkmcnt(5)
    v_mfma_f32_16x16x32_bf16 v[44:47], v[64:67], v[76:79], v[44:47]
    ds_read_b128 v[88:91], v8 offset:47104
    v_mfma_f32_16x16x32_bf16 v[48:51], v[184:187], v[76:79], v[48:51]
    ds_read_b64_tr_b16 v[216:217], v12 offset:32768
    v_mfma_f32_16x16x32_bf16 v[48:51], v[188:191], v[68:71], v[48:51]
    ds_read_b64_tr_b16 v[218:219], v12 offset:33280
    s_waitcnt lgkmcnt(5)
    v_mfma_f32_16x16x32_bf16 v[52:55], v[140:143], v[68:71], v[52:55]
    ds_read_b64_tr_b16 v[220:221], v12 offset:36864
    v_mfma_f32_16x16x32_bf16 v[52:55], v[136:139], v[76:79], v[52:55]
    ds_read_b64_tr_b16 v[222:223], v12 offset:37376
    v_mfma_f32_16x16x32_bf16 v[56:59], v[200:203], v[76:79], v[56:59]
    s_waitcnt lgkmcnt(4)
    v_mfma_f32_16x16x32_bf16 v[56:59], v[204:207], v[68:71], v[56:59]
    v_mfma_f32_16x16x32_bf16 v[60:63], v[92:95], v[68:71], v[60:63]
    v_mfma_f32_16x16x32_bf16 v[60:63], v[88:91], v[76:79], v[60:63]
    s_waitcnt lgkmcnt(0)
    v_mfma_f32_16x16x32_bf16 v[32:35], v[244:247], v[216:219], v[32:35]
    v_mfma_f32_16x16x32_bf16 v[32:35], v[240:243], v[220:223], v[32:35]
    v_mfma_f32_16x16x32_bf16 v[36:39], v[84:87], v[220:223], v[36:39]
    v_mfma_f32_16x16x32_bf16 v[36:39], v[80:83], v[216:219], v[36:39]
    v_mfma_f32_16x16x32_bf16 v[40:43], v[64:67], v[216:219], v[40:43]
    v_mfma_f32_16x16x32_bf16 v[40:43], v[72:75], v[220:223], v[40:43]
    v_mfma_f32_16x16x32_bf16 v[44:47], v[188:191], v[220:223], v[44:47]
    ds_read_b128 v[156:159], v9 offset:37056
    v_mfma_f32_16x16x32_bf16 v[44:47], v[184:187], v[216:219], v[44:47]
    ds_read_b128 v[152:155], v9 offset:36992
    v_mfma_f32_16x16x32_bf16 v[48:51], v[136:139], v[216:219], v[48:51]
    ds_read_b64_tr_b16 v[148:149], v12 offset:40960
    v_mfma_f32_16x16x32_bf16 v[48:51], v[140:143], v[220:223], v[48:51]
    ds_read_b64_tr_b16 v[150:151], v12 offset:41472
    v_mfma_f32_16x16x32_bf16 v[52:55], v[204:207], v[220:223], v[52:55]
    ds_read_b64_tr_b16 v[144:145], v12 offset:45056
    v_mfma_f32_16x16x32_bf16 v[52:55], v[200:203], v[216:219], v[52:55]
    ds_read_b64_tr_b16 v[146:147], v12 offset:45568
    v_mfma_f32_16x16x32_bf16 v[56:59], v[88:91], v[216:219], v[56:59]
    v_mfma_f32_16x16x32_bf16 v[56:59], v[92:95], v[220:223], v[56:59]
    s_waitcnt lgkmcnt(2)
    v_mfma_f32_16x16x32_bf16 v[60:63], v[156:159], v[220:223], v[60:63]
    v_mfma_f32_16x16x32_bf16 v[60:63], v[152:155], v[216:219], v[60:63]
    v_mfma_f32_16x16x32_bf16 v[32:35], v[80:83], v[148:151], v[32:35]
    s_waitcnt lgkmcnt(0)
    v_mfma_f32_16x16x32_bf16 v[32:35], v[84:87], v[144:147], v[32:35]
    v_mfma_f32_16x16x32_bf16 v[36:39], v[72:75], v[144:147], v[36:39]
    v_mfma_f32_16x16x32_bf16 v[36:39], v[64:67], v[148:151], v[36:39]
    v_mfma_f32_16x16x32_bf16 v[40:43], v[184:187], v[148:151], v[40:43]
    v_mfma_f32_16x16x32_bf16 v[40:43], v[188:191], v[144:147], v[40:43]
    s_barrier
    v_mfma_f32_16x16x32_bf16 v[44:47], v[140:143], v[144:147], v[44:47]
    ds_read_b128 v[96:99], v9 offset:37184
    v_mfma_f32_16x16x32_bf16 v[44:47], v[136:139], v[148:151], v[44:47]
    ds_read_b128 v[100:103], v9 offset:37120
    v_mfma_f32_16x16x32_bf16 v[48:51], v[200:203], v[148:151], v[48:51]
    ds_read_b64_tr_b16 v[180:181], v12 offset:49152
    v_mfma_f32_16x16x32_bf16 v[48:51], v[204:207], v[144:147], v[48:51]
    ds_read_b64_tr_b16 v[182:183], v12 offset:49664
    v_mfma_f32_16x16x32_bf16 v[52:55], v[92:95], v[144:147], v[52:55]
    ds_read_b64_tr_b16 v[176:177], v12 offset:53248
    v_mfma_f32_16x16x32_bf16 v[52:55], v[88:91], v[148:151], v[52:55]
    ds_read_b64_tr_b16 v[178:179], v12 offset:53760
    v_mfma_f32_16x16x32_bf16 v[56:59], v[152:155], v[148:151], v[56:59]
    v_mfma_f32_16x16x32_bf16 v[56:59], v[156:159], v[144:147], v[56:59]
    s_waitcnt lgkmcnt(2)
    v_mfma_f32_16x16x32_bf16 v[60:63], v[96:99], v[144:147], v[60:63]
    v_mfma_f32_16x16x32_bf16 v[60:63], v[100:103], v[148:151], v[60:63]
    v_mfma_f32_16x16x32_bf16 v[32:35], v[64:67], v[180:183], v[32:35]
    s_waitcnt lgkmcnt(0)
    v_mfma_f32_16x16x32_bf16 v[32:35], v[72:75], v[176:179], v[32:35]
    v_mfma_f32_16x16x32_bf16 v[36:39], v[188:191], v[176:179], v[36:39]
    v_mfma_f32_16x16x32_bf16 v[36:39], v[184:187], v[180:183], v[36:39]
    v_mfma_f32_16x16x32_bf16 v[40:43], v[136:139], v[180:183], v[40:43]
    v_mfma_f32_16x16x32_bf16 v[40:43], v[140:143], v[176:179], v[40:43]
    v_mfma_f32_16x16x32_bf16 v[44:47], v[204:207], v[176:179], v[44:47]
    ds_read_b128 v[172:175], v9 offset:37312
    v_mfma_f32_16x16x32_bf16 v[44:47], v[200:203], v[180:183], v[44:47]
    ds_read_b128 v[168:171], v9 offset:37248
    v_mfma_f32_16x16x32_bf16 v[48:51], v[88:91], v[180:183], v[48:51]
    ds_read_b64_tr_b16 v[112:113], v12 offset:57344
    v_mfma_f32_16x16x32_bf16 v[48:51], v[92:95], v[176:179], v[48:51]
    ds_read_b64_tr_b16 v[114:115], v12 offset:57856
    v_mfma_f32_16x16x32_bf16 v[52:55], v[156:159], v[176:179], v[52:55]
    ds_read_b64_tr_b16 v[108:109], v12 offset:61440
    v_mfma_f32_16x16x32_bf16 v[52:55], v[152:155], v[180:183], v[52:55]
    ds_read_b64_tr_b16 v[110:111], v12 offset:61952
    v_mfma_f32_16x16x32_bf16 v[56:59], v[100:103], v[180:183], v[56:59]
    v_mfma_f32_16x16x32_bf16 v[56:59], v[96:99], v[176:179], v[56:59]
    s_waitcnt lgkmcnt(2)
    v_mfma_f32_16x16x32_bf16 v[60:63], v[172:175], v[176:179], v[60:63]
    v_mfma_f32_16x16x32_bf16 v[60:63], v[168:171], v[180:183], v[60:63]
    v_mfma_f32_16x16x32_bf16 v[32:35], v[184:187], v[112:115], v[32:35]
    s_waitcnt lgkmcnt(0)
    v_mfma_f32_16x16x32_bf16 v[32:35], v[188:191], v[108:111], v[32:35]
    v_mfma_f32_16x16x32_bf16 v[36:39], v[140:143], v[108:111], v[36:39]
    v_mfma_f32_16x16x32_bf16 v[36:39], v[136:139], v[112:115], v[36:39]
    v_mfma_f32_16x16x32_bf16 v[40:43], v[200:203], v[112:115], v[40:43]
    v_mfma_f32_16x16x32_bf16 v[40:43], v[204:207], v[108:111], v[40:43]
    v_mfma_f32_16x16x32_bf16 v[44:47], v[92:95], v[108:111], v[44:47]
    ds_read_b128 v[104:107], v9 offset:37440
    v_mfma_f32_16x16x32_bf16 v[44:47], v[88:91], v[112:115], v[44:47]
    ds_read_b128 v[116:119], v9 offset:37376
    v_mfma_f32_16x16x32_bf16 v[48:51], v[152:155], v[112:115], v[48:51]
    ds_read_b64_tr_b16 v[120:121], v13 offset:0
    v_mfma_f32_16x16x32_bf16 v[48:51], v[156:159], v[108:111], v[48:51]
    ds_read_b64_tr_b16 v[122:123], v13 offset:512
    v_mfma_f32_16x16x32_bf16 v[52:55], v[96:99], v[108:111], v[52:55]
    ds_read_b64_tr_b16 v[124:125], v13 offset:4096
    v_mfma_f32_16x16x32_bf16 v[52:55], v[100:103], v[112:115], v[52:55]
    ds_read_b64_tr_b16 v[126:127], v13 offset:4608
    v_mfma_f32_16x16x32_bf16 v[56:59], v[168:171], v[112:115], v[56:59]
    v_mfma_f32_16x16x32_bf16 v[56:59], v[172:175], v[108:111], v[56:59]
    s_waitcnt lgkmcnt(2)
    v_mfma_f32_16x16x32_bf16 v[60:63], v[104:107], v[108:111], v[60:63]
    v_mfma_f32_16x16x32_bf16 v[60:63], v[116:119], v[112:115], v[60:63]
    v_mfma_f32_16x16x32_bf16 v[32:35], v[136:139], v[120:123], v[32:35]
    s_waitcnt lgkmcnt(0)
    v_mfma_f32_16x16x32_bf16 v[32:35], v[140:143], v[124:127], v[32:35]
    v_mfma_f32_16x16x32_bf16 v[36:39], v[204:207], v[124:127], v[36:39]
    v_mfma_f32_16x16x32_bf16 v[36:39], v[200:203], v[120:123], v[36:39]
    v_mfma_f32_16x16x32_bf16 v[40:43], v[88:91], v[120:123], v[40:43]
    v_mfma_f32_16x16x32_bf16 v[40:43], v[92:95], v[124:127], v[40:43]
    s_barrier
    v_mfma_f32_16x16x32_bf16 v[44:47], v[156:159], v[124:127], v[44:47]
    ds_read_b128 v[128:131], v28 offset:37056
    v_mfma_f32_16x16x32_bf16 v[44:47], v[152:155], v[120:123], v[44:47]
    ds_read_b128 v[132:135], v28 offset:36992
    v_mfma_f32_16x16x32_bf16 v[48:51], v[100:103], v[120:123], v[48:51]
    ds_read_b64_tr_b16 v[164:165], v13 offset:8192
    v_mfma_f32_16x16x32_bf16 v[48:51], v[96:99], v[124:127], v[48:51]
    ds_read_b64_tr_b16 v[166:167], v13 offset:8704
    v_mfma_f32_16x16x32_bf16 v[52:55], v[172:175], v[124:127], v[52:55]
    ds_read_b64_tr_b16 v[160:161], v13 offset:12288
    v_mfma_f32_16x16x32_bf16 v[52:55], v[168:171], v[120:123], v[52:55]
    ds_read_b64_tr_b16 v[162:163], v13 offset:12800
    v_mfma_f32_16x16x32_bf16 v[56:59], v[116:119], v[120:123], v[56:59]
    v_mfma_f32_16x16x32_bf16 v[56:59], v[104:107], v[124:127], v[56:59]
    s_waitcnt lgkmcnt(2)
    v_mfma_f32_16x16x32_bf16 v[60:63], v[128:131], v[124:127], v[60:63]
    v_mfma_f32_16x16x32_bf16 v[60:63], v[132:135], v[120:123], v[60:63]
    v_mfma_f32_16x16x32_bf16 v[32:35], v[200:203], v[164:167], v[32:35]
    s_waitcnt lgkmcnt(0)
    v_mfma_f32_16x16x32_bf16 v[32:35], v[204:207], v[160:163], v[32:35]
    v_mfma_f32_16x16x32_bf16 v[36:39], v[92:95], v[160:163], v[36:39]
    v_mfma_f32_16x16x32_bf16 v[36:39], v[88:91], v[164:167], v[36:39]
    v_mfma_f32_16x16x32_bf16 v[40:43], v[152:155], v[164:167], v[40:43]
    v_mfma_f32_16x16x32_bf16 v[40:43], v[156:159], v[160:163], v[40:43]
    s_barrier
    v_mfma_f32_16x16x32_bf16 v[44:47], v[96:99], v[160:163], v[44:47]
    ds_read_b128 v[192:195], v28 offset:37184
    v_mfma_f32_16x16x32_bf16 v[44:47], v[100:103], v[164:167], v[44:47]
    ds_read_b128 v[196:199], v28 offset:37120
    v_mfma_f32_16x16x32_bf16 v[48:51], v[168:171], v[164:167], v[48:51]
    ds_read_b64_tr_b16 v[228:229], v13 offset:16384
    v_mfma_f32_16x16x32_bf16 v[48:51], v[172:175], v[160:163], v[48:51]
    ds_read_b64_tr_b16 v[230:231], v13 offset:16896
    v_mfma_f32_16x16x32_bf16 v[52:55], v[104:107], v[160:163], v[52:55]
    ds_read_b64_tr_b16 v[212:213], v13 offset:20480
    v_mfma_f32_16x16x32_bf16 v[52:55], v[116:119], v[164:167], v[52:55]
    ds_read_b64_tr_b16 v[214:215], v13 offset:20992
    v_mfma_f32_16x16x32_bf16 v[56:59], v[132:135], v[164:167], v[56:59]
    v_mfma_f32_16x16x32_bf16 v[56:59], v[128:131], v[160:163], v[56:59]
    s_waitcnt lgkmcnt(2)
    v_mfma_f32_16x16x32_bf16 v[60:63], v[192:195], v[160:163], v[60:63]
    v_mfma_f32_16x16x32_bf16 v[60:63], v[196:199], v[164:167], v[60:63]
    v_mfma_f32_16x16x32_bf16 v[32:35], v[88:91], v[228:231], v[32:35]
    s_waitcnt lgkmcnt(0)
    v_mfma_f32_16x16x32_bf16 v[32:35], v[92:95], v[212:215], v[32:35]
    v_mfma_f32_16x16x32_bf16 v[36:39], v[156:159], v[212:215], v[36:39]
    ds_read_b128 v[224:227], v8 offset:9728
    v_mfma_f32_16x16x32_bf16 v[36:39], v[152:155], v[228:231], v[36:39]
    ds_read_b128 v[208:211], v8 offset:9792
    v_mfma_f32_16x16x32_bf16 v[40:43], v[100:103], v[228:231], v[40:43]
    ds_read_b128 v[236:239], v8 offset:9920
    v_mfma_f32_16x16x32_bf16 v[40:43], v[96:99], v[212:215], v[40:43]
    ds_read_b128 v[232:235], v8 offset:9856
    s_barrier
    v_mfma_f32_16x16x32_bf16 v[44:47], v[172:175], v[212:215], v[44:47]
    ds_read_b128 v[68:71], v28 offset:37312
    v_mfma_f32_16x16x32_bf16 v[44:47], v[168:171], v[228:231], v[44:47]
    ds_read_b128 v[76:79], v28 offset:37248
    v_mfma_f32_16x16x32_bf16 v[48:51], v[116:119], v[228:231], v[48:51]
    ds_read_b64_tr_b16 v[244:245], v13 offset:24576
    v_mfma_f32_16x16x32_bf16 v[48:51], v[104:107], v[212:215], v[48:51]
    ds_read_b64_tr_b16 v[246:247], v13 offset:25088
    v_mfma_f32_16x16x32_bf16 v[52:55], v[128:131], v[212:215], v[52:55]
    ds_read_b64_tr_b16 v[240:241], v13 offset:28672
    v_mfma_f32_16x16x32_bf16 v[52:55], v[132:135], v[228:231], v[52:55]
    ds_read_b64_tr_b16 v[242:243], v13 offset:29184
    v_mfma_f32_16x16x32_bf16 v[56:59], v[196:199], v[228:231], v[56:59]
    ds_read_b128 v[220:223], v8 offset:9984
    v_mfma_f32_16x16x32_bf16 v[56:59], v[192:195], v[212:215], v[56:59]
    ds_read_b128 v[216:219], v8 offset:10048
    s_barrier
    s_waitcnt lgkmcnt(4)
    v_mfma_f32_16x16x32_bf16 v[60:63], v[68:71], v[212:215], v[60:63]
    ds_read_b128 v[80:83], v8 offset:10176
    v_mfma_f32_16x16x32_bf16 v[60:63], v[76:79], v[228:231], v[60:63]
    ds_read_b128 v[84:87], v8 offset:10112
    v_mfma_f32_16x16x32_bf16 v[48:51], v[224:227], v[244:247], v[48:51]
    ds_read_b64_tr_b16 v[144:145], v12 offset:0
    s_waitcnt lgkmcnt(5)
    v_mfma_f32_16x16x32_bf16 v[48:51], v[208:211], v[240:243], v[48:51]
    ds_read_b64_tr_b16 v[146:147], v12 offset:512
    v_mfma_f32_16x16x32_bf16 v[52:55], v[236:239], v[240:243], v[52:55]
    ds_read_b64_tr_b16 v[148:149], v12 offset:4096
    v_mfma_f32_16x16x32_bf16 v[52:55], v[232:235], v[244:247], v[52:55]
    ds_read_b64_tr_b16 v[150:151], v12 offset:4608
    s_waitcnt lgkmcnt(5)
    v_mfma_f32_16x16x32_bf16 v[56:59], v[220:223], v[244:247], v[56:59]
    v_mfma_f32_16x16x32_bf16 v[56:59], v[216:219], v[240:243], v[56:59]
    s_barrier
    v_mfma_f32_16x16x32_bf16 v[60:63], v[80:83], v[240:243], v[60:63]
    ds_read_b128 v[64:67], v9 offset:64
    s_waitcnt lgkmcnt(1)
    v_mfma_f32_16x16x32_bf16 v[60:63], v[84:87], v[244:247], v[60:63]
    ds_read_b128 v[72:75], v9 offset:0
    v_mfma_f32_16x16x32_bf16 v[48:51], v[232:235], v[144:147], v[48:51]
    ds_read_b64_tr_b16 v[176:177], v12 offset:8192
    v_mfma_f32_16x16x32_bf16 v[48:51], v[236:239], v[148:151], v[48:51]
    ds_read_b64_tr_b16 v[178:179], v12 offset:8704
    v_mfma_f32_16x16x32_bf16 v[52:55], v[216:219], v[148:151], v[52:55]
    ds_read_b64_tr_b16 v[180:181], v12 offset:12288
    v_mfma_f32_16x16x32_bf16 v[52:55], v[220:223], v[144:147], v[52:55]
    ds_read_b64_tr_b16 v[182:183], v12 offset:12800
    v_mfma_f32_16x16x32_bf16 v[56:59], v[84:87], v[144:147], v[56:59]
    v_mfma_f32_16x16x32_bf16 v[56:59], v[80:83], v[148:151], v[56:59]
    s_waitcnt lgkmcnt(2)
    v_mfma_f32_16x16x32_bf16 v[60:63], v[64:67], v[148:151], v[60:63]
    ds_read_b128 v[184:187], v9 offset:192
    v_mfma_f32_16x16x32_bf16 v[60:63], v[72:75], v[144:147], v[60:63]
    ds_read_b128 v[188:191], v9 offset:128
    v_mfma_f32_16x16x32_bf16 v[48:51], v[220:223], v[176:179], v[48:51]
    ds_read_b64_tr_b16 v[108:109], v12 offset:16384
    s_waitcnt lgkmcnt(3)
    v_mfma_f32_16x16x32_bf16 v[48:51], v[216:219], v[180:183], v[48:51]
    ds_read_b64_tr_b16 v[110:111], v12 offset:16896
    v_mfma_f32_16x16x32_bf16 v[52:55], v[80:83], v[180:183], v[52:55]
    ds_read_b64_tr_b16 v[112:113], v12 offset:20480
    v_mfma_f32_16x16x32_bf16 v[52:55], v[84:87], v[176:179], v[52:55]
    ds_read_b64_tr_b16 v[114:115], v12 offset:20992
    v_mfma_f32_16x16x32_bf16 v[56:59], v[72:75], v[176:179], v[56:59]
    v_mfma_f32_16x16x32_bf16 v[56:59], v[64:67], v[180:183], v[56:59]
    s_barrier
    s_waitcnt lgkmcnt(2)
    v_mfma_f32_16x16x32_bf16 v[60:63], v[184:187], v[180:183], v[60:63]
    ds_read_b128 v[136:139], v9 offset:320
    v_mfma_f32_16x16x32_bf16 v[60:63], v[188:191], v[176:179], v[60:63]
    ds_read_b128 v[140:143], v9 offset:256
    v_mfma_f32_16x16x32_bf16 v[48:51], v[84:87], v[108:111], v[48:51]
    ds_read_b64_tr_b16 v[124:125], v12 offset:24576
    s_waitcnt lgkmcnt(3)
    v_mfma_f32_16x16x32_bf16 v[48:51], v[80:83], v[112:115], v[48:51]
    ds_read_b64_tr_b16 v[126:127], v12 offset:25088
    v_mfma_f32_16x16x32_bf16 v[52:55], v[64:67], v[112:115], v[52:55]
    ds_read_b64_tr_b16 v[120:121], v12 offset:28672
    v_mfma_f32_16x16x32_bf16 v[52:55], v[72:75], v[108:111], v[52:55]
    ds_read_b64_tr_b16 v[122:123], v12 offset:29184
    v_mfma_f32_16x16x32_bf16 v[56:59], v[188:191], v[108:111], v[56:59]
    v_mfma_f32_16x16x32_bf16 v[56:59], v[184:187], v[112:115], v[56:59]
    s_waitcnt lgkmcnt(2)
    v_mfma_f32_16x16x32_bf16 v[60:63], v[136:139], v[112:115], v[60:63]
    ds_read_b128 v[200:203], v9 offset:448
    v_mfma_f32_16x16x32_bf16 v[60:63], v[140:143], v[108:111], v[60:63]
    ds_read_b128 v[204:207], v9 offset:384
    v_mfma_f32_16x16x32_bf16 v[48:51], v[72:75], v[124:127], v[48:51]
    ds_read_b64_tr_b16 v[160:161], v12 offset:32768
    s_waitcnt lgkmcnt(3)
    v_mfma_f32_16x16x32_bf16 v[48:51], v[64:67], v[120:123], v[48:51]
    ds_read_b64_tr_b16 v[162:163], v12 offset:33280
    v_mfma_f32_16x16x32_bf16 v[52:55], v[184:187], v[120:123], v[52:55]
    ds_read_b64_tr_b16 v[164:165], v12 offset:36864
    v_mfma_f32_16x16x32_bf16 v[52:55], v[188:191], v[124:127], v[52:55]
    ds_read_b64_tr_b16 v[166:167], v12 offset:37376
    v_mfma_f32_16x16x32_bf16 v[56:59], v[140:143], v[124:127], v[56:59]
    v_mfma_f32_16x16x32_bf16 v[56:59], v[136:139], v[120:123], v[56:59]
    s_barrier
    ds_read_b32 v19, v18
    s_waitcnt lgkmcnt(3)
    v_mfma_f32_16x16x32_bf16 v[60:63], v[200:203], v[120:123], v[60:63]
    ds_read_b128 v[88:91], v28 offset:64
    v_mfma_f32_16x16x32_bf16 v[60:63], v[204:207], v[124:127], v[60:63]
    ds_read_b128 v[92:95], v28 offset:0
    v_mfma_f32_16x16x32_bf16 v[48:51], v[188:191], v[160:163], v[48:51]
    ds_read_b64_tr_b16 v[156:157], v12 offset:40960
    s_waitcnt lgkmcnt(4)
    v_mfma_f32_16x16x32_bf16 v[48:51], v[184:187], v[164:167], v[48:51]
    ds_read_b64_tr_b16 v[158:159], v12 offset:41472
    v_mfma_f32_16x16x32_bf16 v[52:55], v[136:139], v[164:167], v[52:55]
    ds_read_b64_tr_b16 v[152:153], v12 offset:45056
    v_mfma_f32_16x16x32_bf16 v[52:55], v[140:143], v[160:163], v[52:55]
    ds_read_b64_tr_b16 v[154:155], v12 offset:45568
    v_mfma_f32_16x16x32_bf16 v[56:59], v[204:207], v[160:163], v[56:59]
    v_mfma_f32_16x16x32_bf16 v[56:59], v[200:203], v[164:167], v[56:59]
    s_waitcnt lgkmcnt(2)
    v_mfma_f32_16x16x32_bf16 v[60:63], v[88:91], v[164:167], v[60:63]
    v_mfma_f32_16x16x32_bf16 v[60:63], v[92:95], v[160:163], v[60:63]
    v_mfma_f32_16x16x32_bf16 v[48:51], v[140:143], v[156:159], v[48:51]
    ds_read_b128 v[100:103], v28 offset:192
    v_readfirstlane_b32 s40, v19
    s_waitcnt lgkmcnt(1)
    v_mfma_f32_16x16x32_bf16 v[48:51], v[136:139], v[152:155], v[48:51]
    ds_read_b128 v[96:99], v28 offset:128
    v_mfma_f32_16x16x32_bf16 v[52:55], v[200:203], v[152:155], v[52:55]
    ds_read_b128 v[172:175], v8 offset:0
    s_cmp_lg_u32 s40, s41
    s_cbranch_scc1 L_decslow_0
L_decback_0:
    v_mfma_f32_16x16x32_bf16 v[52:55], v[204:207], v[156:159], v[52:55]
    ds_read_b128 v[168:171], v8 offset:64
    v_mfma_f32_16x16x32_bf16 v[56:59], v[92:95], v[156:159], v[56:59]
    ds_read_b128 v[116:119], v8 offset:128
    v_mfma_f32_16x16x32_bf16 v[56:59], v[88:91], v[152:155], v[56:59]
    ds_read_b128 v[104:107], v8 offset:192
    s_waitcnt lgkmcnt(3)
    v_mfma_f32_16x16x32_bf16 v[60:63], v[100:103], v[152:155], v[60:63]
    ds_read_b128 v[128:131], v8 offset:320
    v_cvt_pk_bf16_f32 v48, v48, v49
    v_cvt_pk_bf16_f32 v49, v50, v51
    v_mfma_f32_16x16x32_bf16 v[60:63], v[96:99], v[156:159], v[60:63]
    ds_read_b128 v[132:135], v8 offset:256
    v_mfma_f32_16x16x32_bf16 v[32:35], v[172:175], v[244:247], v[32:35]
    v_cvt_pk_bf16_f32 v50, v52, v53
    v_cvt_pk_bf16_f32 v51, v54, v55
    s_waitcnt lgkmcnt(2)
    v_mfma_f32_16x16x32_bf16 v[32:35], v[168:171], v[240:243], v[32:35]
    s_cbranch_scc1 L_slx0_0
    buffer_store_dwordx4 v[48:51], v20, s[28:31], 0 offen offset:0 nt
L_bkx0_0:
    v_mfma_f32_16x16x32_bf16 v[32:35], v[116:119], v[144:147], v[32:35]
    v_cvt_pk_bf16_f32 v56, v56, v57
    v_cvt_pk_bf16_f32 v57, v58, v59
    v_mfma_f32_16x16x32_bf16 v[32:35], v[104:107], v[148:151], v[32:35]
    s_waitcnt lgkmcnt(0)
    v_mfma_f32_16x16x32_bf16 v[36:39], v[128:131], v[148:151], v[36:39]
    ds_read_b128 v[196:199], v8 offset:384
    v_cvt_pk_bf16_f32 v58, v60, v61
    v_cvt_pk_bf16_f32 v59, v62, v63
    v_mfma_f32_16x16x32_bf16 v[36:39], v[132:135], v[144:147], v[36:39]
    ds_read_b128 v[192:195], v8 offset:448
    s_cbranch_scc1 L_slx1_0
    buffer_store_dwordx4 v[56:59], v20, s[28:31], 0 offen offset:1024 nt
L_bkx1_0:
    v_mfma_f32_16x16x32_bf16 v[36:39], v[104:107], v[240:243], v[36:39]
    v_mfma_f32_16x16x32_bf16 v[36:39], v[116:119], v[244:247], v[36:39]
    v_mfma_f32_16x16x32_bf16 v[40:43], v[132:135], v[244:247], v[40:43]
    v_mfma_f32_16x16x32_bf16 v[40:43], v[128:131], v[240:243], v[40:43]
    s_waitcnt lgkmcnt(0)
    v_mfma_f32_16x16x32_bf16 v[40:43], v[196:199], v[144:147], v[40:43]
    v_mfma_f32_16x16x32_bf16 v[40:43], v[192:195], v[148:151], v[40:43]
    v_mfma_f32_16x16x32_bf16 v[44:47], v[208:211], v[148:151], v[44:47]
    v_mfma_f32_16x16x32_bf16 v[44:47], v[224:227], v[144:147], v[44:47]
    v_mfma_f32_16x16x32_bf16 v[44:47], v[192:195], v[240:243], v[44:47]
    v_mfma_f32_16x16x32_bf16 v[44:47], v[196:199], v[244:247], v[44:47]
    v_mfma_f32_16x16x32_bf16 v[32:35], v[132:135], v[176:179], v[32:35]
    v_mfma_f32_16x16x32_bf16 v[32:35], v[128:131], v[180:183], v[32:35]
    v_mfma_f32_16x16x32_bf16 v[32:35], v[196:199], v[108:111], v[32:35]
    v_mfma_f32_16x16x32_bf16 v[32:35], v[192:195], v[112:115], v[32:35]
    v_mfma_f32_16x16x32_bf16 v[36:39], v[208:211], v[112:115], v[36:39]
    v_mfma_f32_16x16x32_bf16 v[36:39], v[224:227], v[108:111], v[36:39]
    v_mfma_f32_16x16x32_bf16 v[36:39], v[192:195], v[180:183], v[36:39]
    v_mfma_f32_16x16x32_bf16 v[36:39], v[196:199], v[176:179], v[36:39]
    v_mfma_f32_16x16x32_bf16 v[40:43], v[224:227], v[176:179], v[40:43]
    s_cbranch_scc1 L_hs_0
L_hsback_0:
    buffer_load_dwordx4 v[52:55], v22, s[28:31], 0 offen offset:0 sc1
    v_mfma_f32_16x16x32_bf16 v[40:43], v[208:211], v[180:183], v[40:43]
    v_mfma_f32_16x16x32_bf16 v[40:43], v[232:235], v[108:111], v[40:43]
    v_mfma_f32_16x16x32_bf16 v[40:43], v[236:239], v[112:115], v[40:43]
    v_mfma_f32_16x16x32_bf16 v[44:47], v[216:219], v[112:115], v[44:47]
    buffer_load_dwordx4 v[60:63], v22, s[28:31], 0 offen offset:1024 sc1
    v_mfma_f32_16x16x32_bf16 v[44:47], v[220:223], v[108:111], v[44:47]
    v_mfma_f32_16x16x32_bf16 v[44:47], v[236:239], v[180:183], v[44:47]
    v_mfma_f32_16x16x32_bf16 v[44:47], v[232:235], v[176:179], v[44:47]
    v_mfma_f32_16x16x32_bf16 v[32:35], v[224:227], v[124:127], v[32:35]
    v_mfma_f32_16x16x32_bf16 v[32:35], v[208:211], v[120:123], v[32:35]
    v_mfma_f32_16x16x32_bf16 v[36:39], v[236:239], v[120:123], v[36:39]
    v_mfma_f32_16x16x32_bf16 v[36:39], v[232:235], v[124:127], v[36:39]
    v_mfma_f32_16x16x32_bf16 v[40:43], v[220:223], v[124:127], v[40:43]
    v_mfma_f32_16x16x32_bf16 v[40:43], v[216:219], v[120:123], v[40:43]
    v_mfma_f32_16x16x32_bf16 v[44:47], v[80:83], v[120:123], v[44:47]
    v_mfma_f32_16x16x32_bf16 v[44:47], v[84:87], v[124:127], v[44:47]
    v_mfma_f32_16x16x32_bf16 v[32:35], v[232:235], v[160:163], v[32:35]
    v_mfma_f32_16x16x32_bf16 v[32:35], v[236:239], v[164:167], v[32:35]
    s_waitcnt vmcnt(1)
L_rck0_0:
    v_max3_u32 v21, v52, v53, v54
    v_mfma_f32_16x16x32_bf16 v[32:35], v[220:223], v[156:159], v[32:35]
    v_max_u32 v21, v21, v55
    v_cmp_eq_u32 vcc, -1, v21
    v_mfma_f32_16x16x32_bf16 v[32:35], v[216:219], v[152:155], v[32:35]
    s_cbranch_vccnz L_rtry0_0
L_rok0_0:
    v_mfma_f32_16x16x32_bf16 v[32:35], v[250:253], v[52:55], v[32:35]
    s_nop 1
    v_mfma_f32_16x16x32_bf16 v[36:39], v[80:83], v[152:155], v[36:39]
    s_waitcnt vmcnt(0)
L_rck1_0:
    v_max3_u32 v21, v60, v61, v62
    v_mfma_f32_16x16x32_bf16 v[36:39], v[84:87], v[156:159], v[36:39]
    v_max_u32 v21, v21, v63
    v_cmp_eq_u32 vcc, -1, v21
    v_mfma_f32_16x16x32_bf16 v[36:39], v[216:219], v[164:167], v[36:39]
    s_cbranch_vccnz L_rtry1_0
L_rok1_0:
    v_mov_b32 v24, v32
    v_mfma_f32_16x16x32_bf16 v[36:39], v[220:223], v[160:163], v[36:39]
    v_mul_f32 v26, v32, v32
    v_add_f32 v24, v24, v33
    v_mfma_f32_16x16x32_bf16 v[36:39], v[248:251], v[52:55], v[36:39]
    v_fmac_f32 v26, v33, v33
    v_add_f32 v24, v24, v34
    v_mfma_f32_16x16x32_bf16 v[40:43], v[84:87], v[160:163], v[40:43]
    v_fmac_f32 v26, v34, v34
    v_add_f32 v24, v24, v35
    v_mfma_f32_16x16x32_bf16 v[40:43], v[80:83], v[164:167], v[40:43]
    v_fmac_f32 v26, v35, v35
    ds_write_b128 v15, v[32:35] offset:0
    v_mfma_f32_16x16x32_bf16 v[40:43], v[72:75], v[156:159], v[40:43]
    v_add_f32 v24, v24, v36
    v_fmac_f32 v26, v36, v36
    v_mfma_f32_16x16x32_bf16 v[40:43], v[64:67], v[152:155], v[40:43]
    v_mov_b32 v25, v37
    v_mul_f32 v27, v37, v37
    v_mfma_f32_16x16x32_bf16 v[40:43], v[250:253], v[60:63], v[40:43]
    v_add_f32 v24, v24, v38
    v_fmac_f32 v26, v38, v38
    v_mfma_f32_16x16x32_bf16 v[44:47], v[184:187], v[152:155], v[44:47]
    v_add_f32 v24, v24, v39
    v_fmac_f32 v26, v39, v39
    v_mfma_f32_16x16x32_bf16 v[44:47], v[188:191], v[156:159], v[44:47]
    ds_write_b128 v15, v[36:39] offset:16
    v_mfma_f32_16x16x32_bf16 v[44:47], v[64:67], v[164:167], v[44:47]
    v_add_f32 v24, v24, v40
    v_fmac_f32 v26, v40, v40
    v_mfma_f32_16x16x32_bf16 v[44:47], v[72:75], v[160:163], v[44:47]
    v_add_f32 v25, v25, v41
    v_fmac_f32 v27, v41, v41
    v_mfma_f32_16x16x32_bf16 v[44:47], v[248:251], v[60:63], v[44:47]
    v_add_f32 v24, v24, v42
    v_fmac_f32 v26, v42, v42
    v_add_f32 v24, v24, v43
    v_fmac_f32 v26, v43, v43
    ds_write_b128 v15, v[40:43] offset:32
    s_nop 2
    v_add_f32 v24, v24, v44
    v_fmac_f32 v26, v44, v44
    v_add_f32 v25, v25, v45
    v_fmac_f32 v27, v45, v45
    v_add_f32 v24, v24, v46
    v_fmac_f32 v26, v46, v46
    v_add_f32 v24, v24, v47
    v_fmac_f32 v26, v47, v47
    v_fmac_f32 v24, v16, v25
    v_fmac_f32 v26, v16, v27
    ds_write_b128 v15, v[44:47] offset:48
    s_nop 0
    v_permlane16_swap_b32 v24, v26
    v_add_f32 v25, v24, v26
    v_add_f32 v24, v24, v26
    s_nop 1
    v_permlane32_swap_b32 v24, v25
    v_add_f32 v24, v24, v25
    v_min_u32 v24, -2, v24
    s_cbranch_scc1 L_ps_0
    buffer_store_dword v24, v14, s[28:31], 0 offen
L_psback_0:
    ds_write_b32 v23, v24
    s_waitcnt lgkmcnt(0)
    s_barrier
    ds_read_b128 v[16:19], v3
    ds_read_b128 v[20:23], v3 offset:8768
    s_branch L_e2
L_rtry0_0:
    buffer_load_dwordx4 v[52:55], v22, s[28:31], 0 offen sc1
    buffer_load_dwordx4 v[60:63], v22, s[28:31], 0 offen offset:1024 sc1
    v_add_u32 v17, 1, v17
    v_cmp_lt_u32 vcc, 0x80000, v17
    s_waitcnt vmcnt(0)
    s_cbranch_vccnz L_rok0_0
    v_max3_u32 v21, v60, v61, v62
    v_max3_u32 v21, v21, v63, v52
    v_max3_u32 v21, v21, v53, v54
    v_max_u32 v21, v21, v55
    v_cmp_eq_u32 vcc, -1, v21
    s_cbranch_vccz L_rok0_0
    s_branch L_rtry0_0
L_rtry1_0:
    buffer_load_dwordx4 v[60:63], v22, s[28:31], 0 offen offset:1024 sc1
    v_add_u32 v17, 1, v17
    v_cmp_lt_u32 vcc, 0x80000, v17
    s_waitcnt vmcnt(0)
    s_cbranch_vccnz L_rok1_0
    v_max3_u32 v21, v60, v61, v62
    v_max_u32 v21, v21, v63
    v_cmp_eq_u32 vcc, -1, v21
    s_cbranch_vccz L_rok1_0
    s_branch L_rtry1_0
.p2align 12
L_stub1:
    s_branch L_stubback
L_var1:
    s_barrier
    v_mfma_f32_16x16x32_bf16 v[36:39], v[108:111], v[208:211], v[36:39]
    ds_read_b128 v[224:227], v28 offset:18624
    v_mfma_f32_16x16x32_bf16 v[40:43], v[104:107], v[208:211], v[40:43]
    ds_read_b64_tr_b16 v[76:77], v12 offset:24576
    v_mfma_f32_16x16x32_bf16 v[40:43], v[116:119], v[212:215], v[40:43]
    ds_read_b128 v[236:239], v8 offset:36992
    v_mfma_f32_16x16x32_bf16 v[44:47], v[120:123], v[212:215], v[44:47]
    ds_read_b64_tr_b16 v[78:79], v12 offset:25088
    v_mfma_f32_16x16x32_bf16 v[44:47], v[124:127], v[208:211], v[44:47]
    ds_read_b64_tr_b16 v[68:69], v12 offset:28672
    v_mfma_f32_16x16x32_bf16 v[48:51], v[128:131], v[208:211], v[48:51]
    ds_read_b128 v[232:235], v8 offset:37056
    v_mfma_f32_16x16x32_bf16 v[48:51], v[132:135], v[212:215], v[48:51]
    ds_read_b64_tr_b16 v[70:71], v12 offset:29184
    v_mfma_f32_16x16x32_bf16 v[52:55], v[164:167], v[212:215], v[52:55]
    ds_read_b128 v[240:243], v8 offset:37184
    v_mfma_f32_16x16x32_bf16 v[52:55], v[160:163], v[208:211], v[52:55]
    ds_read_b128 v[244:247], v8 offset:37120
    v_mfma_f32_16x16x32_bf16 v[56:59], v[192:195], v[208:211], v[56:59]
    ds_read_b128 v[80:83], v8 offset:37248
    v_mfma_f32_16x16x32_bf16 v[56:59], v[196:199], v[212:215], v[56:59]
    ds_read_b128 v[84:87], v8 offset:37312
    s_waitcnt lgkmcnt(7)
    v_mfma_f32_16x16x32_bf16 v[60:63], v[228:231], v[212:215], v[60:63]
    ds_read_b128 v[72:75], v8 offset:37440
    v_mfma_f32_16x16x32_bf16 v[60:63], v[224:227], v[208:211], v[60:63]
    ds_read_b128 v[64:67], v8 offset:37376
    v_mfma_f32_16x16x32_bf16 v[32:35], v[236:239], v[76:79], v[32:35]
    ds_read_b128 v[184:187], v8 offset:46720
    s_waitcnt lgkmcnt(5)
    v_mfma_f32_16x16x32_bf16 v[32:35], v[232:235], v[68:71], v[32:35]
    ds_read_b128 v[188:191], v8 offset:46784
    v_mfma_f32_16x16x32_bf16 v[36:39], v[240:243], v[68:71], v[36:39]
    ds_read_b128 v[140:143], v8 offset:46912
    v_mfma_f32_16x16x32_bf16 v[36:39], v[244:247], v[76:79], v[36:39]
    ds_read_b128 v[136:139], v8 offset:46848
    s_waitcnt lgkmcnt(5)
    v_mfma_f32_16x16x32_bf16 v[40:43], v[80:83], v[76:79], v[40:43]
    ds_read_b128 v[200:203], v8 offset:46976
    v_mfma_f32_16x16x32_bf16 v[40:43], v[84:87], v[68:71], v[40:43]
    ds_read_b128 v[204:207], v8 offset:47040
    s_barrier
    v_mfma_f32_16x16x32_bf16 v[44:47], v[72:75], v[68:71], v[44:47]
    ds_read_b128 v[92:95], v8 offset:47168
    s_waitcnt lgkmcnt(5)
    v_mfma_f32_16x16x32_bf16 v[44:47], v[64:67], v[76:79], v[44:47]
    ds_read_b128 v[88:91], v8 offset:47104
    v_mfma_f32_16x16x32_bf16 v[48:51], v[184:187], v[76:79], v[48:51]
    ds_read_b64_tr_b16 v[216:217], v12 offset:32768
    v_mfma_f32_16x16x32_bf16 v[48:51], v[188:191], v[68:71], v[48:51]
    ds_read_b64_tr_b16 v[218:219], v12 offset:33280
    s_waitcnt lgkmcnt(5)
    v_mfma_f32_16x16x32_bf16 v[52:55], v[140:143], v[68:71], v[52:55]
    ds_read_b64_tr_b16 v[220:221], v12 offset:36864
    v_mfma_f32_16x16x32_bf16 v[52:55], v[136:139], v[76:79], v[52:55]
    ds_read_b64_tr_b16 v[222:223], v12 offset:37376
    v_mfma_f32_16x16x32_bf16 v[56:59], v[200:203], v[76:79], v[56:59]
    s_waitcnt lgkmcnt(4)
    v_mfma_f32_16x16x32_bf16 v[56:59], v[204:207], v[68:71], v[56:59]
    v_mfma_f32_16x16x32_bf16 v[60:63], v[92:95], v[68:71], v[60:63]
    v_mfma_f32_16x16x32_bf16 v[60:63], v[88:91], v[76:79], v[60:63]
    s_waitcnt lgkmcnt(0)
    v_mfma_f32_16x16x32_bf16 v[32:35], v[244:247], v[216:219], v[32:35]
    v_mfma_f32_16x16x32_bf16 v[32:35], v[240:243], v[220:223], v[32:35]
    v_mfma_f32_16x16x32_bf16 v[36:39], v[84:87], v[220:223], v[36:39]
    v_mfma_f32_16x16x32_bf16 v[36:39], v[80:83], v[216:219], v[36:39]
    v_mfma_f32_16x16x32_bf16 v[40:43], v[64:67], v[216:219], v[40:43]
    v_mfma_f32_16x16x32_bf16 v[40:43], v[72:75], v[220:223], v[40:43]
    v_mfma_f32_16x16x32_bf16 v[44:47], v[188:191], v[220:223], v[44:47]
    ds_read_b128 v[156:159], v9 offset:37056
    v_mfma_f32_16x16x32_bf16 v[44:47], v[184:187], v[216:219], v[44:47]
    ds_read_b128 v[152:155], v9 offset:36992
    v_mfma_f32_16x16x32_bf16 v[48:51], v[136:139], v[216:219], v[48:51]
    ds_read_b64_tr_b16 v[148:149], v12 offset:40960
    v_mfma_f32_16x16x32_bf16 v[48:51], v[140:143], v[220:223], v[48:51]
    ds_read_b64_tr_b16 v[150:151], v12 offset:41472
    v_mfma_f32_16x16x32_bf16 v[52:55], v[204:207], v[220:223], v[52:55]
    ds_read_b64_tr_b16 v[144:145], v12 offset:45056
    v_mfma_f32_16x16x32_bf16 v[52:55], v[200:203], v[216:219], v[52:55]
    ds_read_b64_tr_b16 v[146:147], v12 offset:45568
    v_mfma_f32_16x16x32_bf16 v[56:59], v[88:91], v[216:219], v[56:59]
    v_mfma_f32_16x16x32_bf16 v[56:59], v[92:95], v[220:223], v[56:59]
    s_waitcnt lgkmcnt(2)
    v_mfma_f32_16x16x32_bf16 v[60:63], v[156:159], v[220:223], v[60:63]
    v_mfma_f32_16x16x32_bf16 v[60:63], v[152:155], v[216:219], v[60:63]
    v_mfma_f32_16x16x32_bf16 v[32:35], v[80:83], v[148:151], v[32:35]
    s_waitcnt lgkmcnt(0)
    v_mfma_f32_16x16x32_bf16 v[32:35], v[84:87], v[144:147], v[32:35]
    v_mfma_f32_16x16x32_bf16 v[36:39], v[72:75], v[144:147], v[36:39]
    v_mfma_f32_16x16x32_bf16 v[36:39], v[64:67], v[148:151], v[36:39]
    v_mfma_f32_16x16x32_bf16 v[40:43], v[184:187], v[148:151], v[40:43]
    v_mfma_f32_16x16x32_bf16 v[40:43], v[188:191], v[144:147], v[40:43]
    s_barrier
    v_mfma_f32_16x16x32_bf16 v[44:47], v[140:143], v[144:147], v[44:47]
    ds_read_b128 v[96:99], v9 offset:37184
    v_mfma_f32_16x16x32_bf16 v[44:47], v[136:139], v[148:151], v[44:47]
    ds_read_b128 v[100:103], v9 offset:37120
    v_mfma_f32_16x16x32_bf16 v[48:51], v[200:203], v[148:151], v[48:51]
    ds_read_b64_tr_b16 v[180:181], v12 offset:49152
    v_mfma_f32_16x16x32_bf16 v[48:51], v[204:207], v[144:147], v[48:51]
    ds_read_b64_tr_b16 v[182:183], v12 offset:49664
    v_mfma_f32_16x16x32_bf16 v[52:55], v[92:95], v[144:147], v[52:55]
    ds_read_b64_tr_b16 v[176:177], v12 offset:53248
    v_mfma_f32_16x16x32_bf16 v[52:55], v[88:91], v[148:151], v[52:55]
    ds_read_b64_tr_b16 v[178:179], v12 offset:53760
    v_mfma_f32_16x16x32_bf16 v[56:59], v[152:155], v[148:151], v[56:59]
    v_mfma_f32_16x16x32_bf16 v[56:59], v[156:159], v[144:147], v[56:59]
    s_waitcnt lgkmcnt(2)
    v_mfma_f32_16x16x32_bf16 v[60:63], v[96:99], v[144:147], v[60:63]
    v_mfma_f32_16x16x32_bf16 v[60:63], v[100:103], v[148:151], v[60:63]
    v_mfma_f32_16x16x32_bf16 v[32:35], v[64:67], v[180:183], v[32:35]
    s_waitcnt lgkmcnt(0)
    v_mfma_f32_16x16x32_bf16 v[32:35], v[72:75], v[176:179], v[32:35]
    v_mfma_f32_16x16x32_bf16 v[36:39], v[188:191], v[176:179], v[36:39]
    v_mfma_f32_16x16x32_bf16 v[36:39], v[184:187], v[180:183], v[36:39]
    v_mfma_f32_16x16x32_bf16 v[40:43], v[136:139], v[180:183], v[40:43]
    v_mfma_f32_16x16x32_bf16 v[40:43], v[140:143], v[176:179], v[40:43]
    v_mfma_f32_16x16x32_bf16 v[44:47], v[204:207], v[176:179], v[44:47]
    ds_read_b128 v[172:175], v9 offset:37312
    v_mfma_f32_16x16x32_bf16 v[44:47], v[200:203], v[180:183], v[44:47]
    ds_read_b128 v[168:171], v9 offset:37248
    v_mfma_f32_16x16x32_bf16 v[48:51], v[88:91], v[180:183], v[48:51]
    ds_read_b64_tr_b16 v[112:113], v12 offset:57344
    v_mfma_f32_16x16x32_bf16 v[48:51], v[92:95], v[176:179], v[48:51]
    ds_read_b64_tr_b16 v[114:115], v12 offset:57856
    v_mfma_f32_16x16x32_bf16 v[52:55], v[156:159], v[176:179], v[52:55]
    ds_read_b64_tr_b16 v[108:109], v12 offset:61440
    v_mfma_f32_16x16x32_bf16 v[52:55], v[152:155], v[180:183], v[52:55]
    ds_read_b64_tr_b16 v[110:111], v12 offset:61952
    v_mfma_f32_16x16x32_bf16 v[56:59], v[100:103], v[180:183], v[56:59]
    v_mfma_f32_16x16x32_bf16 v[56:59], v[96:99], v[176:179], v[56:59]
    s_waitcnt lgkmcnt(2)
    v_mfma_f32_16x16x32_bf16 v[60:63], v[172:175], v[176:179], v[60:63]
    v_mfma_f32_16x16x32_bf16 v[60:63], v[168:171], v[180:183], v[60:63]
    v_mfma_f32_16x16x32_bf16 v[32:35], v[184:187], v[112:115], v[32:35]
    s_waitcnt lgkmcnt(0)
    v_mfma_f32_16x16x32_bf16 v[32:35], v[188:191], v[108:111], v[32:35]
    v_mfma_f32_16x16x32_bf16 v[36:39], v[140:143], v[108:111], v[36:39]
    v_mfma_f32_16x16x32_bf16 v[36:39], v[136:139], v[112:115], v[36:39]
    v_mfma_f32_16x16x32_bf16 v[40:43], v[200:203], v[112:115], v[40:43]
    v_mfma_f32_16x16x32_bf16 v[40:43], v[204:207], v[108:111], v[40:43]
    v_mfma_f32_16x16x32_bf16 v[44:47], v[92:95], v[108:111], v[44:47]
    ds_read_b128 v[104:107], v9 offset:37440
    v_mfma_f32_16x16x32_bf16 v[44:47], v[88:91], v[112:115], v[44:47]
    ds_read_b128 v[116:119], v9 offset:37376
    v_mfma_f32_16x16x32_bf16 v[48:51], v[152:155], v[112:115], v[48:51]
    ds_read_b64_tr_b16 v[120:121], v13 offset:0
    v_mfma_f32_16x16x32_bf16 v[48:51], v[156:159], v[108:111], v[48:51]
    ds_read_b64_tr_b16 v[122:123], v13 offset:512
    v_mfma_f32_16x16x32_bf16 v[52:55], v[96:99], v[108:111], v[52:55]
    ds_read_b64_tr_b16 v[124:125], v13 offset:4096
    v_mfma_f32_16x16x32_bf16 v[52:55], v[100:103], v[112:115], v[52:55]
    ds_read_b64_tr_b16 v[126:127], v13 offset:4608
    v_mfma_f32_16x16x32_bf16 v[56:59], v[168:171], v[112:115], v[56:59]
    v_mfma_f32_16x16x32_bf16 v[56:59], v[172:175], v[108:111], v[56:59]
    s_waitcnt lgkmcnt(2)
    v_mfma_f32_16x16x32_bf16 v[60:63], v[104:107], v[108:111], v[60:63]
    v_mfma_f32_16x16x32_bf16 v[60:63], v[116:119], v[112:115], v[60:63]
    v_mfma_f32_16x16x32_bf16 v[32:35], v[136:139], v[120:123], v[32:35]
    s_waitcnt lgkmcnt(0)
    v_mfma_f32_16x16x32_bf16 v[32:35], v[140:143], v[124:127], v[32:35]
    v_mfma_f32_16x16x32_bf16 v[36:39], v[204:207], v[124:127], v[36:39]
    v_mfma_f32_16x16x32_bf16 v[36:39], v[200:203], v[120:123], v[36:39]
    v_mfma_f32_16x16x32_bf16 v[40:43], v[88:91], v[120:123], v[40:43]
    v_mfma_f32_16x16x32_bf16 v[40:43], v[92:95], v[124:127], v[40:43]
    s_barrier
    v_mfma_f32_16x16x32_bf16 v[44:47], v[156:159], v[124:127], v[44:47]
    ds_read_b128 v[128:131], v28 offset:37056
    v_mfma_f32_16x16x32_bf16 v[44:47], v[152:155], v[120:123], v[44:47]
    ds_read_b128 v[132:135], v28 offset:36992
    v_mfma_f32_16x16x32_bf16 v[48:51], v[100:103], v[120:123], v[48:51]
    ds_read_b64_tr_b16 v[164:165], v13 offset:8192
    v_mfma_f32_16x16x32_bf16 v[48:51], v[96:99], v[124:127], v[48:51]
    ds_read_b64_tr_b16 v[166:167], v13 offset:8704
    v_mfma_f32_16x16x32_bf16 v[52:55], v[172:175], v[124:127], v[52:55]
    ds_read_b64_tr_b16 v[160:161], v13 offset:12288
    v_mfma_f32_16x16x32_bf16 v[52:55], v[168:171], v[120:123], v[52:55]
    ds_read_b64_tr_b16 v[162:163], v13 offset:12800
    v_mfma_f32_16x16x32_bf16 v[56:59], v[116:119], v[120:123], v[56:59]
    v_mfma_f32_16x16x32_bf16 v[56:59], v[104:107], v[124:127], v[56:59]
    s_waitcnt lgkmcnt(2)
    v_mfma_f32_16x16x32_bf16 v[60:63], v[128:131], v[124:127], v[60:63]
    v_mfma_f32_16x16x32_bf16 v[60:63], v[132:135], v[120:123], v[60:63]
    v_mfma_f32_16x16x32_bf16 v[32:35], v[200:203], v[164:167], v[32:35]
    s_waitcnt lgkmcnt(0)
    v_mfma_f32_16x16x32_bf16 v[32:35], v[204:207], v[160:163], v[32:35]
    v_mfma_f32_16x16x32_bf16 v[36:39], v[92:95], v[160:163], v[36:39]
    v_mfma_f32_16x16x32_bf16 v[36:39], v[88:91], v[164:167], v[36:39]
    v_mfma_f32_16x16x32_bf16 v[40:43], v[152:155], v[164:167], v[40:43]
    v_mfma_f32_16x16x32_bf16 v[40:43], v[156:159], v[160:163], v[40:43]
    s_barrier
    v_mfma_f32_16x16x32_bf16 v[44:47], v[96:99], v[160:163], v[44:47]
    ds_read_b128 v[192:195], v28 offset:37184
    v_mfma_f32_16x16x32_bf16 v[44:47], v[100:103], v[164:167], v[44:47]
    ds_read_b128 v[196:199], v28 offset:37120
    v_mfma_f32_16x16x32_bf16 v[48:51], v[168:171], v[164:167], v[48:51]
    ds_read_b64_tr_b16 v[228:229], v13 offset:16384
    v_mfma_f32_16x16x32_bf16 v[48:51], v[172:175], v[160:163], v[48:51]
    ds_read_b64_tr_b16 v[230:231], v13 offset:16896
    v_mfma_f32_16x16x32_bf16 v[52:55], v[104:107], v[160:163], v[52:55]
    ds_read_b64_tr_b16 v[212:213], v13 offset:20480
    v_mfma_f32_16x16x32_bf16 v[52:55], v[116:119], v[164:167], v[52:55]
    ds_read_b64_tr_b16 v[214:215], v13 offset:20992
    v_mfma_f32_16x16x32_bf16 v[56:59], v[132:135], v[164:167], v[56:59]
    v_mfma_f32_16x16x32_bf16 v[56:59], v[128:131], v[160:163], v[56:59]
    s_waitcnt lgkmcnt(2)
    v_mfma_f32_16x16x32_bf16 v[60:63], v[192:195], v[160:163], v[60:63]
    v_mfma_f32_16x16x32_bf16 v[60:63], v[196:199], v[164:167], v[60:63]
    v_mfma_f32_16x16x32_bf16 v[32:35], v[88:91], v[228:231], v[32:35]
    s_waitcnt lgkmcnt(0)
    v_mfma_f32_16x16x32_bf16 v[32:35], v[92:95], v[212:215], v[32:35]
    v_mfma_f32_16x16x32_bf16 v[36:39], v[156:159], v[212:215], v[36:39]
    ds_read_b128 v[224:227], v8 offset:0
    v_mfma_f32_16x16x32_bf16 v[36:39], v[152:155], v[228:231], v[36:39]
    ds_read_b128 v[208:211], v8 offset:64
    v_mfma_f32_16x16x32_bf16 v[40:43], v[100:103], v[228:231], v[40:43]
    ds_read_b128 v[236:239], v8 offset:192
    v_mfma_f32_16x16x32_bf16 v[40:43], v[96:99], v[212:215], v[40:43]
    ds_read_b128 v[232:235], v8 offset:128
    s_barrier
    v_mfma_f32_16x16x32_bf16 v[44:47], v[172:175], v[212:215], v[44:47]
    ds_read_b128 v[68:71], v28 offset:37312
    v_mfma_f32_16x16x32_bf16 v[44:47], v[168:171], v[228:231], v[44:47]
    ds_read_b128 v[76:79], v28 offset:37248
    v_mfma_f32_16x16x32_bf16 v[48:51], v[116:119], v[228:231], v[48:51]
    ds_read_b64_tr_b16 v[244:245], v13 offset:24576
    v_mfma_f32_16x16x32_bf16 v[48:51], v[104:107], v[212:215], v[48:51]
    ds_read_b64_tr_b16 v[246:247], v13 offset:25088
    v_mfma_f32_16x16x32_bf16 v[52:55], v[128:131], v[212:215], v[52:55]
    ds_read_b64_tr_b16 v[240:241], v13 offset:28672
    v_mfma_f32_16x16x32_bf16 v[52:55], v[132:135], v[228:231], v[52:55]
    ds_read_b64_tr_b16 v[242:243], v13 offset:29184
    v_mfma_f32_16x16x32_bf16 v[56:59], v[196:199], v[228:231], v[56:59]
    ds_read_b128 v[220:223], v8 offset:256
    v_mfma_f32_16x16x32_bf16 v[56:59], v[192:195], v[212:215], v[56:59]
    ds_read_b128 v[216:219], v8 offset:320
    s_barrier
    s_waitcnt lgkmcnt(4)
    v_mfma_f32_16x16x32_bf16 v[60:63], v[68:71], v[212:215], v[60:63]
    ds_read_b128 v[80:83], v8 offset:448
    v_mfma_f32_16x16x32_bf16 v[60:63], v[76:79], v[228:231], v[60:63]
    ds_read_b128 v[84:87], v8 offset:384
    v_mfma_f32_16x16x32_bf16 v[32:35], v[224:227], v[244:247], v[32:35]
    ds_read_b64_tr_b16 v[144:145], v12 offset:0
    s_waitcnt lgkmcnt(5)
    v_mfma_f32_16x16x32_bf16 v[32:35], v[208:211], v[240:243], v[32:35]
    ds_read_b64_tr_b16 v[146:147], v12 offset:512
    v_mfma_f32_16x16x32_bf16 v[36:39], v[236:239], v[240:243], v[36:39]
    ds_read_b64_tr_b16 v[148:149], v12 offset:4096
    v_mfma_f32_16x16x32_bf16 v[36:39], v[232:235], v[244:247], v[36:39]
    ds_read_b64_tr_b16 v[150:151], v12 offset:4608
    s_waitcnt lgkmcnt(5)
    v_mfma_f32_16x16x32_bf16 v[40:43], v[220:223], v[244:247], v[40:43]
    v_mfma_f32_16x16x32_bf16 v[40:43], v[216:219], v[240:243], v[40:43]
    s_barrier
    v_mfma_f32_16x16x32_bf16 v[44:47], v[80:83], v[240:243], v[44:47]
    ds_read_b128 v[64:67], v8 offset:9792
    s_waitcnt lgkmcnt(1)
    v_mfma_f32_16x16x32_bf16 v[44:47], v[84:87], v[244:247], v[44:47]
    ds_read_b128 v[72:75], v8 offset:9728
    v_mfma_f32_16x16x32_bf16 v[32:35], v[232:235], v[144:147], v[32:35]
    ds_read_b64_tr_b16 v[176:177], v12 offset:8192
    v_mfma_f32_16x16x32_bf16 v[32:35], v[236:239], v[148:151], v[32:35]
    ds_read_b64_tr_b16 v[178:179], v12 offset:8704
    v_mfma_f32_16x16x32_bf16 v[36:39], v[216:219], v[148:151], v[36:39]
    ds_read_b64_tr_b16 v[180:181], v12 offset:12288
    v_mfma_f32_16x16x32_bf16 v[36:39], v[220:223], v[144:147], v[36:39]
    ds_read_b64_tr_b16 v[182:183], v12 offset:12800
    v_mfma_f32_16x16x32_bf16 v[40:43], v[84:87], v[144:147], v[40:43]
    v_mfma_f32_16x16x32_bf16 v[40:43], v[80:83], v[148:151], v[40:43]
    s_waitcnt lgkmcnt(2)
    v_mfma_f32_16x16x32_bf16 v[44:47], v[64:67], v[148:151], v[44:47]
    ds_read_b128 v[184:187], v8 offset:9920
    v_mfma_f32_16x16x32_bf16 v[44:47], v[72:75], v[144:147], v[44:47]
    ds_read_b128 v[188:191], v8 offset:9856
    v_mfma_f32_16x16x32_bf16 v[32:35], v[220:223], v[176:179], v[32:35]
    ds_read_b64_tr_b16 v[108:109], v12 offset:16384
    s_waitcnt lgkmcnt(3)
    v_mfma_f32_16x16x32_bf16 v[32:35], v[216:219], v[180:183], v[32:35]
    ds_read_b64_tr_b16 v[110:111], v12 offset:16896
    v_mfma_f32_16x16x32_bf16 v[36:39], v[80:83], v[180:183], v[36:39]
    ds_read_b64_tr_b16 v[112:113], v12 offset:20480
    v_mfma_f32_16x16x32_bf16 v[36:39], v[84:87], v[176:179], v[36:39]
    ds_read_b64_tr_b16 v[114:115], v12 offset:20992
    v_mfma_f32_16x16x32_bf16 v[40:43], v[72:75], v[176:179], v[40:43]
    v_mfma_f32_16x16x32_bf16 v[40:43], v[64:67], v[180:183], v[40:43]
    s_barrier
    s_waitcnt lgkmcnt(2)
    v_mfma_f32_16x16x32_bf16 v[44:47], v[184:187], v[180:183], v[44:47]
    ds_read_b128 v[136:139], v8 offset:10048
    v_mfma_f32_16x16x32_bf16 v[44:47], v[188:191], v[176:179], v[44:47]
    ds_read_b128 v[140:143], v8 offset:9984
    v_mfma_f32_16x16x32_bf16 v[32:35], v[84:87], v[108:111], v[32:35]
    ds_read_b64_tr_b16 v[124:125], v12 offset:24576
    s_waitcnt lgkmcnt(3)
    v_mfma_f32_16x16x32_bf16 v[32:35], v[80:83], v[112:115], v[32:35]
    ds_read_b64_tr_b16 v[126:127], v12 offset:25088
    v_mfma_f32_16x16x32_bf16 v[36:39], v[64:67], v[112:115], v[36:39]
    ds_read_b64_tr_b16 v[120:121], v12 offset:28672
    v_mfma_f32_16x16x32_bf16 v[36:39], v[72:75], v[108:111], v[36:39]
    ds_read_b64_tr_b16 v[122:123], v12 offset:29184
    v_mfma_f32_16x16x32_bf16 v[40:43], v[188:191], v[108:111], v[40:43]
    v_mfma_f32_16x16x32_bf16 v[40:43], v[184:187], v[112:115], v[40:43]
    s_waitcnt lgkmcnt(2)
    v_mfma_f32_16x16x32_bf16 v[44:47], v[136:139], v[112:115], v[44:47]
    ds_read_b128 v[200:203], v8 offset:10176
    v_mfma_f32_16x16x32_bf16 v[44:47], v[140:143], v[108:111], v[44:47]
    ds_read_b128 v[204:207], v8 offset:10112
    v_mfma_f32_16x16x32_bf16 v[32:35], v[72:75], v[124:127], v[32:35]
    ds_read_b64_tr_b16 v[160:161], v12 offset:32768
    s_waitcnt lgkmcnt(3)
    v_mfma_f32_16x16x32_bf16 v[32:35], v[64:67], v[120:123], v[32:35]
    ds_read_b64_tr_b16 v[162:163], v12 offset:33280
    v_mfma_f32_16x16x32_bf16 v[36:39], v[184:187], v[120:123], v[36:39]
    ds_read_b64_tr_b16 v[164:165], v12 offset:36864
    v_mfma_f32_16x16x32_bf16 v[36:39], v[188:191], v[124:127], v[36:39]
    ds_read_b64_tr_b16 v[166:167], v12 offset:37376
    v_mfma_f32_16x16x32_bf16 v[40:43], v[140:143], v[124:127], v[40:43]
    v_mfma_f32_16x16x32_bf16 v[40:43], v[136:139], v[120:123], v[40:43]
    s_barrier
    ds_read_b32 v19, v18
    s_waitcnt lgkmcnt(3)
    v_mfma_f32_16x16x32_bf16 v[44:47], v[200:203], v[120:123], v[44:47]
    ds_read_b128 v[88:91], v9 offset:64
    v_mfma_f32_16x16x32_bf16 v[44:47], v[204:207], v[124:127], v[44:47]
    ds_read_b128 v[92:95], v9 offset:0
    v_mfma_f32_16x16x32_bf16 v[32:35], v[188:191], v[160:163], v[32:35]
    ds_read_b64_tr_b16 v[156:157], v12 offset:40960
    s_waitcnt lgkmcnt(4)
    v_mfma_f32_16x16x32_bf16 v[32:35], v[184:187], v[164:167], v[32:35]
    ds_read_b64_tr_b16 v[158:159], v12 offset:41472
    v_mfma_f32_16x16x32_bf16 v[36:39], v[136:139], v[164:167], v[36:39]
    ds_read_b64_tr_b16 v[152:153], v12 offset:45056
    v_mfma_f32_16x16x32_bf16 v[36:39], v[140:143], v[160:163], v[36:39]
    ds_read_b64_tr_b16 v[154:155], v12 offset:45568
    v_mfma_f32_16x16x32_bf16 v[40:43], v[204:207], v[160:163], v[40:43]
    v_mfma_f32_16x16x32_bf16 v[40:43], v[200:203], v[164:167], v[40:43]
    s_waitcnt lgkmcnt(2)
    v_mfma_f32_16x16x32_bf16 v[44:47], v[88:91], v[164:167], v[44:47]
    v_mfma_f32_16x16x32_bf16 v[44:47], v[92:95], v[160:163], v[44:47]
    v_mfma_f32_16x16x32_bf16 v[32:35], v[140:143], v[156:159], v[32:35]
    ds_read_b128 v[100:103], v9 offset:192
    v_readfirstlane_b32 s40, v19
    s_waitcnt lgkmcnt(1)
    v_mfma_f32_16x16x32_bf16 v[32:35], v[136:139], v[152:155], v[32:35]
    ds_read_b128 v[96:99], v9 offset:128
    v_mfma_f32_16x16x32_bf16 v[36:39], v[200:203], v[152:155], v[36:39]
    s_cmp_lg_u32 s40, s41
    s_cbranch_scc1 L_decslow_1
L_decback_1:
    v_mfma_f32_16x16x32_bf16 v[36:39], v[204:207], v[156:159], v[36:39]
    v_mfma_f32_16x16x32_bf16 v[40:43], v[92:95], v[156:159], v[40:43]
    v_mfma_f32_16x16x32_bf16 v[40:43], v[88:91], v[152:155], v[40:43]
    s_waitcnt lgkmcnt(0)
    v_mfma_f32_16x16x32_bf16 v[44:47], v[100:103], v[152:155], v[44:47]
    v_cvt_pk_bf16_f32 v32, v32, v33
    v_cvt_pk_bf16_f32 v33, v34, v35
    v_mfma_f32_16x16x32_bf16 v[44:47], v[96:99], v[156:159], v[44:47]
    v_mfma_f32_16x16x32_bf16 v[48:51], v[72:75], v[244:247], v[48:51]
    v_cvt_pk_bf16_f32 v34, v36, v37
    v_cvt_pk_bf16_f32 v35, v38, v39
    v_mfma_f32_16x16x32_bf16 v[48:51], v[64:67], v[240:243], v[48:51]
    s_cbranch_scc1 L_slx0_1
    buffer_store_dwordx4 v[32:35], v20, s[28:31], 0 offen offset:0 nt
L_bkx0_1:
    v_mfma_f32_16x16x32_bf16 v[48:51], v[188:191], v[144:147], v[48:51]
    v_cvt_pk_bf16_f32 v40, v40, v41
    v_cvt_pk_bf16_f32 v41, v42, v43
    v_mfma_f32_16x16x32_bf16 v[48:51], v[184:187], v[148:151], v[48:51]
    v_mfma_f32_16x16x32_bf16 v[52:55], v[136:139], v[148:151], v[52:55]
    v_cvt_pk_bf16_f32 v42, v44, v45
    v_cvt_pk_bf16_f32 v43, v46, v47
    v_mfma_f32_16x16x32_bf16 v[52:55], v[140:143], v[144:147], v[52:55]
    s_cbranch_scc1 L_slx1_1
    buffer_store_dwordx4 v[40:43], v20, s[28:31], 0 offen offset:1024 nt
L_bkx1_1:
    v_mfma_f32_16x16x32_bf16 v[52:55], v[184:187], v[240:243], v[52:55]
    v_mfma_f32_16x16x32_bf16 v[52:55], v[188:191], v[244:247], v[52:55]
    v_mfma_f32_16x16x32_bf16 v[56:59], v[140:143], v[244:247], v[56:59]
    v_mfma_f32_16x16x32_bf16 v[56:59], v[136:139], v[240:243], v[56:59]
    v_mfma_f32_16x16x32_bf16 v[56:59], v[204:207], v[144:147], v[56:59]
    v_mfma_f32_16x16x32_bf16 v[56:59], v[200:203], v[148:151], v[56:59]
    v_mfma_f32_16x16x32_bf16 v[60:63], v[88:91], v[148:151], v[60:63]
    v_mfma_f32_16x16x32_bf16 v[60:63], v[92:95], v[144:147], v[60:63]
    v_mfma_f32_16x16x32_bf16 v[60:63], v[200:203], v[240:243], v[60:63]
    v_mfma_f32_16x16x32_bf16 v[60:63], v[204:207], v[244:247], v[60:63]
    v_mfma_f32_16x16x32_bf16 v[48:51], v[140:143], v[176:179], v[48:51]
    v_mfma_f32_16x16x32_bf16 v[48:51], v[136:139], v[180:183], v[48:51]
    v_mfma_f32_16x16x32_bf16 v[48:51], v[204:207], v[108:111], v[48:51]
    v_mfma_f32_16x16x32_bf16 v[48:51], v[200:203], v[112:115], v[48:51]
    v_mfma_f32_16x16x32_bf16 v[52:55], v[88:91], v[112:115], v[52:55]
    v_mfma_f32_16x16x32_bf16 v[52:55], v[92:95], v[108:111], v[52:55]
    v_mfma_f32_16x16x32_bf16 v[52:55], v[200:203], v[180:183], v[52:55]
    ds_read_b128 v[172:175], v9 offset:320
    v_mfma_f32_16x16x32_bf16 v[52:55], v[204:207], v[176:179], v[52:55]
    ds_read_b128 v[168:171], v9 offset:256
    v_mfma_f32_16x16x32_bf16 v[56:59], v[92:95], v[176:179], v[56:59]
    s_cbranch_scc1 L_hs_1
L_hsback_1:
    buffer_load_dwordx4 v[36:39], v22, s[28:31], 0 offen offset:0 sc1
    v_mfma_f32_16x16x32_bf16 v[56:59], v[88:91], v[180:183], v[56:59]
    v_mfma_f32_16x16x32_bf16 v[56:59], v[96:99], v[108:111], v[56:59]
    v_mfma_f32_16x16x32_bf16 v[56:59], v[100:103], v[112:115], v[56:59]
    s_waitcnt lgkmcnt(0)
    v_mfma_f32_16x16x32_bf16 v[60:63], v[172:175], v[112:115], v[60:63]
    buffer_load_dwordx4 v[44:47], v22, s[28:31], 0 offen offset:1024 sc1
    v_mfma_f32_16x16x32_bf16 v[60:63], v[168:171], v[108:111], v[60:63]
    v_mfma_f32_16x16x32_bf16 v[60:63], v[100:103], v[180:183], v[60:63]
    v_mfma_f32_16x16x32_bf16 v[60:63], v[96:99], v[176:179], v[60:63]
    v_mfma_f32_16x16x32_bf16 v[48:51], v[92:95], v[124:127], v[48:51]
    ds_read_b128 v[116:119], v9 offset:448
    v_mfma_f32_16x16x32_bf16 v[48:51], v[88:91], v[120:123], v[48:51]
    ds_read_b128 v[104:107], v9 offset:384
    v_mfma_f32_16x16x32_bf16 v[52:55], v[100:103], v[120:123], v[52:55]
    v_mfma_f32_16x16x32_bf16 v[52:55], v[96:99], v[124:127], v[52:55]
    v_mfma_f32_16x16x32_bf16 v[56:59], v[168:171], v[124:127], v[56:59]
    v_mfma_f32_16x16x32_bf16 v[56:59], v[172:175], v[120:123], v[56:59]
    ds_read_b128 v[128:131], v28 offset:128
    s_waitcnt lgkmcnt(1)
    v_mfma_f32_16x16x32_bf16 v[60:63], v[116:119], v[120:123], v[60:63]
    ds_read_b128 v[132:135], v28 offset:192
    v_mfma_f32_16x16x32_bf16 v[60:63], v[104:107], v[124:127], v[60:63]
    ds_read_b128 v[196:199], v28 offset:64
    v_mfma_f32_16x16x32_bf16 v[48:51], v[96:99], v[160:163], v[48:51]
    ds_read_b128 v[192:195], v28 offset:0
    v_mfma_f32_16x16x32_bf16 v[48:51], v[100:103], v[164:167], v[48:51]
    s_waitcnt vmcnt(1)
L_rck0_1:
    v_max3_u32 v21, v36, v37, v38
    v_mfma_f32_16x16x32_bf16 v[48:51], v[168:171], v[156:159], v[48:51]
    v_max_u32 v21, v21, v39
    v_cmp_eq_u32 vcc, -1, v21
    v_mfma_f32_16x16x32_bf16 v[48:51], v[172:175], v[152:155], v[48:51]
    s_cbranch_vccnz L_rtry0_1
L_rok0_1:
    v_mfma_f32_16x16x32_bf16 v[48:51], v[250:253], v[36:39], v[48:51]
    s_nop 1
    v_mfma_f32_16x16x32_bf16 v[52:55], v[116:119], v[152:155], v[52:55]
    s_waitcnt vmcnt(0)
L_rck1_1:
    v_max3_u32 v21, v44, v45, v46
    v_mfma_f32_16x16x32_bf16 v[52:55], v[104:107], v[156:159], v[52:55]
    v_max_u32 v21, v21, v47
    v_cmp_eq_u32 vcc, -1, v21
    v_mfma_f32_16x16x32_bf16 v[52:55], v[172:175], v[164:167], v[52:55]
    s_cbranch_vccnz L_rtry1_1
L_rok1_1:
    v_mov_b32 v24, v48
    v_mfma_f32_16x16x32_bf16 v[52:55], v[168:171], v[160:163], v[52:55]
    v_mul_f32 v26, v48, v48
    v_mov_b32 v25, v49
    v_mfma_f32_16x16x32_bf16 v[52:55], v[248:251], v[36:39], v[52:55]
    v_mul_f32 v27, v49, v49
    v_add_f32 v24, v24, v50
    v_mfma_f32_16x16x32_bf16 v[56:59], v[104:107], v[160:163], v[56:59]
    v_fmac_f32 v26, v50, v50
    v_add_f32 v24, v24, v51
    v_mfma_f32_16x16x32_bf16 v[56:59], v[116:119], v[164:167], v[56:59]
    v_fmac_f32 v26, v51, v51
    ds_write_b128 v15, v[48:51] offset:0
    s_waitcnt lgkmcnt(1)
    v_mfma_f32_16x16x32_bf16 v[56:59], v[192:195], v[156:159], v[56:59]
    v_add_f32 v24, v24, v52
    v_fmac_f32 v26, v52, v52
    v_mfma_f32_16x16x32_bf16 v[56:59], v[196:199], v[152:155], v[56:59]
    v_add_f32 v25, v25, v53
    v_fmac_f32 v27, v53, v53
    v_mfma_f32_16x16x32_bf16 v[56:59], v[250:253], v[44:47], v[56:59]
    v_add_f32 v24, v24, v54
    v_fmac_f32 v26, v54, v54
    v_mfma_f32_16x16x32_bf16 v[60:63], v[132:135], v[152:155], v[60:63]
    v_add_f32 v24, v24, v55
    v_fmac_f32 v26, v55, v55
    v_mfma_f32_16x16x32_bf16 v[60:63], v[128:131], v[156:159], v[60:63]
    ds_write_b128 v15, v[52:55] offset:16
    v_mfma_f32_16x16x32_bf16 v[60:63], v[196:199], v[164:167], v[60:63]
    v_add_f32 v24, v24, v56
    v_fmac_f32 v26, v56, v56
    v_mfma_f32_16x16x32_bf16 v[60:63], v[192:195], v[160:163], v[60:63]
    v_add_f32 v25, v25, v57
    v_fmac_f32 v27, v57, v57
    v_mfma_f32_16x16x32_bf16 v[60:63], v[248:251], v[44:47], v[60:63]
    v_add_f32 v24, v24, v58
    v_fmac_f32 v26, v58, v58
    v_add_f32 v24, v24, v59
    v_fmac_f32 v26, v59, v59
    ds_write_b128 v15, v[56:59] offset:32
    s_nop 2
    v_add_f32 v24, v24, v60
    v_fmac_f32 v26, v60, v60
    v_add_f32 v25, v25, v61
    v_fmac_f32 v27, v61, v61
    v_add_f32 v24, v24, v62
    v_fmac_f32 v26, v62, v62
    v_add_f32 v24, v24, v63
    v_fmac_f32 v26, v63, v63
    v_fmac_f32 v24, v16, v25
    v_fmac_f32 v26, v16, v27
    ds_write_b128 v15, v[60:63] offset:48
    s_nop 0
    v_permlane16_swap_b32 v24, v26
    v_add_f32 v25, v24, v26
    v_add_f32 v24, v24, v26
    s_nop 1
    v_permlane32_swap_b32 v24, v25
    v_add_f32 v24, v24, v25
    v_min_u32 v24, -2, v24
    s_cbranch_scc1 L_ps_1
    buffer_store_dword v24, v14, s[28:31], 0 offen
L_psback_1:
    ds_write_b32 v23, v24
    s_waitcnt lgkmcnt(0)
    s_barrier
    ds_read_b128 v[16:19], v3
    ds_read_b128 v[20:23], v3 offset:8768
    s_branch L_e2
L_rtry0_1:
    buffer_load_dwordx4 v[36:39], v22, s[28:31], 0 offen sc1
    buffer_load_dwordx4 v[44:47], v22, s[28:31], 0 offen offset:1024 sc1
    v_add_u32 v17, 1, v17
    v_cmp_lt_u32 vcc, 0x80000, v17
    s_waitcnt vmcnt(0)
    s_cbranch_vccnz L_rok0_1
    v_max3_u32 v21, v44, v45, v46
    v_max3_u32 v21, v21, v47, v36
    v_max3_u32 v21, v21, v37, v38
    v_max_u32 v21, v21, v39
    v_cmp_eq_u32 vcc, -1, v21
    s_cbranch_vccz L_rok0_1
    s_branch L_rtry0_1
L_rtry1_1:
    buffer_load_dwordx4 v[44:47], v22, s[28:31], 0 offen offset:1024 sc1
    v_add_u32 v17, 1, v17
    v_cmp_lt_u32 vcc, 0x80000, v17
    s_waitcnt vmcnt(0)
    s_cbranch_vccnz L_rok1_1
    v_max3_u32 v21, v44, v45, v46
    v_max_u32 v21, v21, v47
    v_cmp_eq_u32 vcc, -1, v21
    s_cbranch_vccz L_rok1_1
    s_branch L_rtry1_1
L_last:
.section .rodata,"a"
.p2align 6
.amdhsa_kernel standalone__self_sup_conv_stem_wavlm__speech_kernel
  .amdhsa_next_free_vgpr 256
  .amdhsa_next_free_sgpr 102
  .amdhsa_accum_offset 256
  .amdhsa_group_segment_fixed_size 0
  .amdhsa_kernarg_size 56
  .amdhsa_user_sgpr_count 2
  .amdhsa_user_sgpr_kernarg_segment_ptr 1
  .amdhsa_system_sgpr_workgroup_id_x 1
.end_amdhsa_kernel
```
